```python
import torch

def _softmax(x, axis=-1):
    return torch.softmax(x, dim=axis)
def _gelu(x):
    return torch.nn.functional.gelu(x, approximate="tanh")
def _silu(x):
    return torch.nn.functional.silu(x)
def _sigmoid(x):
    return torch.sigmoid(x)
def _layernorm(x, axis=-1, eps=1e-5):
    m = x.mean(dim=axis, keepdim=True)
    v = x.var(dim=axis, keepdim=True, unbiased=False)
    return (x - m) / torch.sqrt(v + eps)
def _scatter_add(tgt, idx, src, axis=0):
    return tgt.clone().index_add_(axis, idx, src)
def _segment_sum(src, seg, n):
    out = torch.zeros((n,) + src.shape[1:], dtype=src.dtype)
    return out.index_add_(0, seg, src)
def _pad(x, pw):
    flat = tuple(v for pair in reversed(pw) for v in pair)
    return torch.nn.functional.pad(x, flat)

kernel_name = 'interleave_layers__spectral_fnet__spectral_fnet__prompt'

def setup_inputs():

    _w = (lambda a: (lambda t: t.to(torch.bfloat16) if t.is_floating_point() else t)(torch.as_tensor(a)))
    def _A_setup():
        B, S, D = 1, 2048, 640
        ns = torch.arange(S)[:, None] * torch.arange(S)[None, :]
        nd = torch.arange(D)[:, None] * torch.arange(D)[None, :]
        Ws_re = torch.cos(-2.0 * torch.pi * ns / S).to(float)
        Ws_im = torch.sin(-2.0 * torch.pi * ns / S).to(float)
        Wd_re = torch.cos(-2.0 * torch.pi * nd / D).to(float)
        Wd_im = torch.sin(-2.0 * torch.pi * nd / D).to(float)
        return {
            "x": _w((lambda *s: torch.randn(*s, dtype=torch.bfloat16) * 0.05)(B, S, D)),
            "dft_seq_re": _w(Ws_re),
            "dft_seq_im": _w(Ws_im),
            "dft_hid_re": _w(Wd_re),
            "dft_hid_im": _w(Wd_im),
        }
    _A_in = _A_setup()

    def _B_setup():
        B, S, D = 1, 2048, 640
        ns = torch.arange(S)[:, None] * torch.arange(S)[None, :]
        nd = torch.arange(D)[:, None] * torch.arange(D)[None, :]
        Ws_re = torch.cos(-2.0 * torch.pi * ns / S).to(float)
        Ws_im = torch.sin(-2.0 * torch.pi * ns / S).to(float)
        Wd_re = torch.cos(-2.0 * torch.pi * nd / D).to(float)
        Wd_im = torch.sin(-2.0 * torch.pi * nd / D).to(float)
        return {
            "x": _w((lambda *s: torch.randn(*s, dtype=torch.bfloat16) * 0.05)(B, S, D)),
            "dft_seq_re": _w(Ws_re),
            "dft_seq_im": _w(Ws_im),
            "dft_hid_re": _w(Wd_re),
            "dft_hid_im": _w(Wd_im),
        }
    _B_in = _B_setup()

    return {
        "A_x": _A_in["x"],
        "A_dft_seq_re": _A_in["dft_seq_re"],
        "A_dft_seq_im": _A_in["dft_seq_im"],
        "A_dft_hid_re": _A_in["dft_hid_re"],
        "A_dft_hid_im": _A_in["dft_hid_im"],
        "B_x": _B_in["x"],
        "B_dft_seq_re": _B_in["dft_seq_re"],
        "B_dft_seq_im": _B_in["dft_seq_im"],
        "B_dft_hid_re": _B_in["dft_hid_re"],
        "B_dft_hid_im": _B_in["dft_hid_im"],
    }

def reference(A_x, A_dft_seq_re, A_dft_seq_im, A_dft_hid_re, A_dft_hid_im, B_x, B_dft_seq_re, B_dft_seq_im, B_dft_hid_re, B_dft_hid_im):
    def _A_ref(x, dft_seq_re, dft_seq_im, dft_hid_re, dft_hid_im):
        a = torch.einsum("bsd,ed->bse", x, dft_hid_re)
        b = torch.einsum("bsd,ed->bse", x, dft_hid_im)
        y = torch.einsum("ts,bse->bte", dft_seq_re, a) - torch.einsum("ts,bse->bte", dft_seq_im, b)
        return y

    def _B_ref(x, dft_seq_re, dft_seq_im, dft_hid_re, dft_hid_im):
        a = torch.einsum("bsd,ed->bse", x, dft_hid_re)
        b = torch.einsum("bsd,ed->bse", x, dft_hid_im)
        y = torch.einsum("ts,bse->bte", dft_seq_re, a) - torch.einsum("ts,bse->bte", dft_seq_im, b)
        return y

    x = A_x
    x = x + _A_ref(_layernorm(x, axis=-1), A_dft_seq_re, A_dft_seq_im, A_dft_hid_re, A_dft_hid_im)
    x = x + _B_ref(_layernorm(x, axis=-1), B_dft_seq_re, B_dft_seq_im, B_dft_hid_re, B_dft_hid_im)
    x = x + _A_ref(_layernorm(x, axis=-1), A_dft_seq_re, A_dft_seq_im, A_dft_hid_re, A_dft_hid_im)
    x = x + _B_ref(_layernorm(x, axis=-1), B_dft_seq_re, B_dft_seq_im, B_dft_hid_re, B_dft_hid_im)
    return x
```

```asm
; @launch grid=(256,1,1) block=(512,1,1) lds=64000
.amdgcn_target "amdgcn-amd-amdhsa--gfx950"
.text
.globl interleave_layers__spectral_fnet__spectral_fnet__prompt_kernel
.p2align 8
.type interleave_layers__spectral_fnet__spectral_fnet__prompt_kernel,@function
interleave_layers__spectral_fnet__spectral_fnet__prompt_kernel:
    s_cmp_ge_u32 s2, 256
    s_cbranch_scc1 Lend
    s_load_dwordx2 s[4:5], s[0:1], 0
    s_load_dwordx2 s[52:53], s[0:1], 80
    s_load_dwordx2 s[56:57], s[0:1], 96
    s_getpc_b64 s[24:25]
Lpc:
    s_add_u32 s24, s24, fft_tables - Lpc
    s_addc_u32 s25, s25, 0
    v_lshrrev_b32 v3, 6, v0
    v_and_b32 v1, 63, v0
    v_readfirstlane_b32 s26, v3
    v_lshlrev_b32 v2, 4, v1
    s_and_b32 s20, s2, 7
    s_lshr_b32 s21, s2, 3
    s_sub_u32 s33, 16, s20
    s_cmp_eq_u32 s20, 0
    s_cselect_b32 s33, 8, s33
    s_cmp_ge_u32 s21, 16
    s_cselect_b32 s22, s33, s20
    s_lshl_b32 s33, s21, 3
    s_and_b32 s33, s33, 0x70
    s_add_u32 s22, s22, s33
    s_and_b32 s23, s21, 1
    s_lshl_b32 s27, s22, 1
    s_add_u32 s27, s27, s23
    s_mul_i32 s33, s26, 3072
    s_mov_b32 s49, s33
    s_cmp_lt_u32 s26, 6
    s_cbranch_scc1 Ldma
    s_lshl_b32 s33, s20, 12
    s_add_u32 s33, s33, 17408
    s_movk_i32 s49, 17408
    s_cmp_eq_u32 s26, 7
    s_cbranch_scc1 Ldma
    s_cmp_gt_u32 s22, 64
    s_cselect_b32 s33, 2, 0
    s_cmp_eq_u32 s22, 0
    s_cselect_b32 s33, 4, s33
    s_cmp_eq_u32 s22, 64
    s_cselect_b32 s33, 6, s33
    s_add_u32 s33, s33, s23
    s_lshl_b32 s33, s33, 11
    s_add_u32 s33, s33, 50176
    s_movk_i32 s49, 21504
Ldma:
    s_add_u32 s66, s24, s33
    s_addc_u32 s67, s25, 0
    s_add_u32 m0, s49, 27648
    s_cmp_eq_u32 s26, 7
    global_load_lds_dwordx4 v2, s[66:67]
    global_load_lds_dwordx4 v2, s[66:67] offset:1024
    s_cbranch_scc0 Ldma2
    global_load_lds_dwordx4 v2, s[66:67] offset:3072
Ldma2:
    s_sub_u32 s33, s26, 5
    s_cmp_lt_u32 s33, 2
    s_cbranch_scc1 Ldmadone
    global_load_lds_dwordx4 v2, s[66:67] offset:2048
Ldmadone:
    s_mov_b32 s10, 2621440
    s_mov_b32 s11, 0x20000
    s_mov_b32 s14, 2621440
    s_mov_b32 s15, 0x20000
    s_mov_b32 s18, 6627328
    s_mov_b32 s19, 0x20000
    s_cmp_lt_u32 s21, 20
    s_cselect_b32 s47, 1, 0
    s_lshl_b32 s28, s20, 5
    s_add_u32 s28, s28, s21
    s_mul_i32 s28, s28, 5120
    s_add_u32 s28, s28, 73728
    v_lshrrev_b32 v228, 3, v1
    s_lshl_b32 s33, s26, 3
    s_lshl_b32 s49, s20, 6
    s_add_u32 s33, s33, s49
    v_add_u32 v3, s33, v228
    v_mul_u32_u24 v129, 2560, v3
    v_and_b32 v229, 7, v1
    s_lshl_b32 s33, s21, 7
    v_lshl_add_u32 v129, v229, 4, v129
    v_add_u32_e64 v129, s33, v129
    s_cmp_eq_u32 s27, 0
    s_cselect_b32 s48, 5, 4
    s_cmp_lt_u32 s26, s48
    s_cselect_b32 s48, 1, 0
    s_cbranch_scc0 Lhelper
    s_lshl_b32 s49, s23, 10
    s_lshl_b32 s50, s26, 8
    s_add_u32 s50, s50, s49
    s_add_u32 s50, s50, s22
    s_add_u32 s59, s26, 4
    s_lshl_b32 s33, s26, 8
    s_sub_u32 s33, 1920, s33
    s_sub_u32 s49, 7, s26
    s_cmp_eq_u32 s27, 1
    s_cselect_b32 s50, s33, s50
    s_cselect_b32 s59, s49, s59
    s_sub_u32 s49, 8, s26
    s_and_b32 s49, s49, 7
    s_cmp_eq_u32 s27, 0
    s_cselect_b32 s59, s49, s59
    s_sub_u32 s51, 2048, s50
    s_and_b32 s51, s51, 2047
    s_mul_i32 s50, s50, 1280
    s_mul_i32 s51, s51, 1280
    s_mul_i32 s54, s26, 2560
    s_add_u32 s54, s54, 51200
    s_mov_b32 m0, s54
    s_waitcnt lgkmcnt(0)
    s_mov_b32 s8, s4
    s_mov_b32 s9, s5
    buffer_load_dwordx4 v2, s[8:11], s50 offen lds
    s_mov_b64 exec, 0xffff
    buffer_load_dwordx4 v2, s[8:11], s50 offen offset:1024 lds
    s_mov_b64 exec, -1
    s_add_u32 m0, s54, 1280
    s_nop 0
    buffer_load_dwordx4 v2, s[8:11], s51 offen lds
    s_mov_b64 exec, 0xffff
    buffer_load_dwordx4 v2, s[8:11], s51 offen offset:1024 lds
    s_mov_b64 exec, -1
    s_mov_b32 s16, s56
    s_mov_b32 s17, s57
    v_lshrrev_b32 v3, 4, v1
    v_mul_u32_u24 v3, 320, v3
    v_and_b32 v93, 15, v1
    v_lshl_add_u32 v3, v93, 1, v3
    v_add_u32 v91, s54, v3
    s_add_u32 s33, s54, 2272
    v_sub_u32 v92, s33, v3
    v_add_u32 v93, 288, v92
    s_add_u32 s33, s54, 1280
    v_mov_b32 v136, s33
    v_cmp_eq_u32 vcc, 0, v1
    s_nop 1
    v_cndmask_b32 v93, v93, v136, vcc
    s_waitcnt vmcnt(4)
    s_branch Lcommon
Lhelper:
    s_cmp_eq_u32 s26, 6
    s_cbranch_scc0 Lnopf
    s_sub_u32 s66, s24, fft_tables - Lpc
    s_subb_u32 s67, s25, 0
    v_lshlrev_b32 v3, 7, v1
    v_min_u32 v3, fft_tables - Lpc, v3
    global_load_dword v130, v3, s[66:67]
Lnopf:
    v_mov_b32 v212, -1
    v_mov_b32 v213, -1
    v_mov_b32 v214, -1
    v_mov_b32 v215, -1
    v_mov_b32 v3, 4096
    s_waitcnt lgkmcnt(0)
    s_mov_b32 s8, s4
    s_mov_b32 s9, s5
    s_mov_b32 s16, s56
    s_mov_b32 s17, s57
    buffer_load_dword v132, v3, s[16:19], 0 offen sc1
    s_cmp_eq_u32 s26, 7
    s_cbranch_scc0 Le6
    s_add_u32 s33, s28, 4096
    buffer_store_dwordx4 v[212:215], v2, s[16:19], s28 offen offset:0 sc1
    buffer_store_dwordx4 v[212:215], v2, s[16:19], s28 offen offset:1024 sc1
    buffer_store_dwordx4 v[212:215], v2, s[16:19], s28 offen offset:2048 sc1
    buffer_store_dwordx4 v[212:215], v2, s[16:19], s28 offen offset:3072 sc1
    buffer_store_dwordx4 v[212:215], v2, s[16:19], s33 offen sc1
    s_waitcnt vmcnt(6)
    s_branch Lcommon
Le6:
    s_cmp_eq_u32 s26, 5
    s_cbranch_scc0 Le5
    s_cmp_eq_u32 s47, 0
    s_cbranch_scc1 Le5
    s_mov_b32 s33, 1282048
    buffer_store_dwordx4 v[212:215], v129, s[16:19], s33 offen sc1
    s_add_u32 s33, s33, 20480
    buffer_store_dwordx4 v[212:215], v129, s[16:19], s33 offen sc1
    s_add_u32 s33, s33, 20480
    buffer_store_dwordx4 v[212:215], v129, s[16:19], s33 offen sc1
    s_add_u32 s33, s33, 20480
    buffer_store_dwordx4 v[212:215], v129, s[16:19], s33 offen sc1
    s_add_u32 s33, s33, 20480
    buffer_store_dwordx4 v[212:215], v129, s[16:19], s33 offen sc1
    s_add_u32 s33, s33, 20480
    buffer_store_dwordx4 v[212:215], v129, s[16:19], s33 offen sc1
    s_add_u32 s33, s33, 20480
    buffer_store_dwordx4 v[212:215], v129, s[16:19], s33 offen sc1
    s_add_u32 s33, s33, 20480
    buffer_store_dwordx4 v[212:215], v129, s[16:19], s33 offen sc1
    s_waitcnt vmcnt(9)
    s_branch Lcommon
Le5:
    s_cmp_eq_u32 s26, 6
    s_cbranch_scc0 Lw1
    v_mov_b32 v3, 27392
    v_mov_b32 v136, 0
    ds_write_b32 v3, v136 offset:8
    s_waitcnt vmcnt(2) lgkmcnt(0)
    s_branch Lcommon
    s_nop 0
Lw1:
    s_waitcnt vmcnt(1)
Lcommon:
    s_barrier
    s_mov_b32 s12, s52
    s_mov_b32 s13, s53
    s_cmp_eq_u32 s48, 0
    s_cbranch_scc1 Lnotr1
    ds_read_b128 v[72:75], v2 offset:39936
    ds_read_b128 v[76:79], v2 offset:40960
    ds_read_b128 v[80:83], v2 offset:41984
    ds_read_b128 v[24:27], v2 offset:27648
    ds_read_b128 v[28:31], v2 offset:28672
    ds_read_b128 v[64:67], v2 offset:37888
    ds_read_b128 v[68:71], v2 offset:38912
Lnotr1:
    v_mov_b32 v3, v0
    v_lshlrev_b32 v88, 4, v3
    v_add_u32 v88, s28, v88
    v_lshrrev_b32 v90, 1, v3
    v_and_b32 v3, 1, v3
    v_mul_u32_u24 v3, 784, v3
    v_add_lshl_u32 v90, v90, v3, 2
    v_mov_b32 v182, 0
    v_mov_b32 v183, 0
    v_mov_b32 v186, 0
    v_mov_b32 v187, 0
    v_mov_b32 v94, 0x3acccccd
    s_sub_u32 s33, 128, s22
    s_min_u32 s33, s33, s22
    s_and_b32 s33, s33, 63
    s_mul_i32 s33, s33, 2560
    s_lshl_b32 s49, s26, 8
    s_add_u32 s33, s33, s49
    v_lshrrev_b32 v3, 4, v1
    v_mul_u32_u24 v89, 163840, v3
    v_and_b32 v233, 15, v1
    v_lshl_add_u32 v89, v233, 4, v89
    v_add_u32 v89, s33, v89
    v_mul_u32_u24 v3, 3072, v3
    v_lshl_add_u32 v3, v233, 3, v3
    s_lshl_b32 s33, s26, 7
    s_add_u32 s33, s33, 0
    v_add_u32 v95, s33, v3
    v_add_u32 v131, 256, v95
    v_mov_b32 v124, 0
    s_sub_u32 s33, s21, 20
    s_cmp_lt_u32 s21, 20
    s_cselect_b32 s33, s21, s33
    s_lshl_b32 s49, s20, 5
    s_add_u32 s33, s33, s49
    s_lshl_b32 s33, s33, 7
    s_lshl_b32 s49, s26, 2
    s_add_u32 s33, s33, s49
    s_add_u32 s33, s33, 40960
    v_mov_b32 v135, s33
    s_mov_b32 s39, 0x3acccccd
    s_mov_b32 s40, 0x3727c5ac
    s_mov_b32 s41, 1
    s_mov_b32 s29, 0
    s_mov_b32 s30, 0
    s_mov_b32 s31, 1384448
    s_cmp_eq_u32 s48, 0
    s_cbranch_scc1 Lhelp2
    s_cmp_eq_u32 s59, s26
    s_cselect_b32 s45, 1, 0
    s_lshl_b32 s36, s45, 23
    s_lshl_b32 s37, s45, 31
    s_mul_i32 s55, s26, 1536
    s_mul_i32 s61, s59, 1536
    s_lshr_b32 s33, s26, 2
    s_mul_i32 s33, s33, 3136
    s_and_b32 s58, s26, 3
    s_mul_i32 s58, s58, 768
    s_add_u32 s58, s58, s33
    s_lshr_b32 s33, s59, 2
    s_mul_i32 s33, s33, 3136
    s_and_b32 s59, s59, 3
    s_mul_i32 s59, s59, 768
    s_add_u32 s59, s59, s33
    s_lshl_b32 s33, s45, 2
    v_mov_b32 v3, s55
    v_mov_b32 v136, s61
    v_mov_b32 v137, s33
    v_cmp_lt_u32 vcc, 31, v1
    s_nop 1
    v_cndmask_b32 v3, v3, v136, vcc
    v_cndmask_b32 v137, 0, v137, vcc
    s_waitcnt lgkmcnt(4)
    v_xor_b32 v72, v72, v137
    v_xor_b32 v73, v73, v137
    v_add_u32 v72, v72, v3
    v_add_u32 v73, v73, v3
    v_add_u32 v74, v74, v3
    v_add_u32 v75, v75, v3
    v_add_u32 v76, v76, v3
    v_add_u32 v77, v77, v3
    v_add_u32 v84, s59, v80
    v_add_u32 v80, s58, v80
    v_add_u32 v85, s59, v81
    v_add_u32 v81, s58, v81
    v_add_u32 v86, s59, v82
    v_add_u32 v82, s58, v82
    v_add_u32 v87, s59, v83
    v_add_u32_e64 v83, s58, v83
    ds_read_b128 v[32:35], v2 offset:29696
    ds_read_b128 v[36:39], v2 offset:30720
    ds_read_b128 v[40:43], v2 offset:31744
    ds_read_b128 v[44:47], v2 offset:32768
    ds_read_b128 v[48:51], v2 offset:33792
    ds_read_b128 v[52:55], v2 offset:34816
    ds_read_b128 v[56:59], v2 offset:35840
    ds_read_b128 v[60:63], v2 offset:36864
    s_waitcnt vmcnt(0)
    s_nop 0
    ds_read_u16_d16_hi v4, v91 offset:0
    ds_read_u16_d16_hi v6, v91 offset:32
    ds_read_u16_d16_hi v8, v91 offset:64
    ds_read_u16_d16_hi v10, v91 offset:96
    ds_read_u16_d16_hi v12, v91 offset:128
    ds_read_u16_d16_hi v5, v91 offset:160
    ds_read_u16_d16_hi v7, v91 offset:192
    ds_read_u16_d16_hi v9, v91 offset:224
    ds_read_u16_d16_hi v11, v91 offset:256
    ds_read_u16_d16_hi v13, v91 offset:288
    ds_read_u16_d16_hi v14, v93
    ds_read_u16_d16_hi v16, v92 offset:256
    ds_read_u16_d16_hi v18, v92 offset:224
    ds_read_u16_d16_hi v20, v92 offset:192
    ds_read_u16_d16_hi v22, v92 offset:160
    ds_read_u16_d16_hi v15, v92 offset:128
    ds_read_u16_d16_hi v17, v92 offset:96
    ds_read_u16_d16_hi v19, v92 offset:64
    ds_read_u16_d16_hi v21, v92 offset:32
    ds_read_u16_d16_hi v23, v92 offset:0
    s_waitcnt lgkmcnt(0)
    s_nop 0
    v_pk_mul_f32 v[164:165], v[4:5], v[4:5]
    v_pk_mul_f32 v[168:169], v[14:15], v[14:15]
    v_pk_add_f32 v[162:163], v[4:5], v[6:7]
    v_pk_add_f32 v[166:167], v[14:15], v[16:17]
    v_pk_fma_f32 v[164:165], v[6:7], v[6:7], v[164:165]
    v_pk_fma_f32 v[168:169], v[16:17], v[16:17], v[168:169]
    v_pk_add_f32 v[162:163], v[162:163], v[8:9]
    v_pk_add_f32 v[166:167], v[166:167], v[18:19]
    v_pk_fma_f32 v[164:165], v[8:9], v[8:9], v[164:165]
    v_pk_fma_f32 v[168:169], v[18:19], v[18:19], v[168:169]
    v_pk_add_f32 v[162:163], v[162:163], v[10:11]
    v_pk_add_f32 v[166:167], v[166:167], v[20:21]
    v_pk_fma_f32 v[164:165], v[10:11], v[10:11], v[164:165]
    v_pk_fma_f32 v[168:169], v[20:21], v[20:21], v[168:169]
    v_pk_add_f32 v[162:163], v[162:163], v[12:13]
    v_pk_add_f32 v[166:167], v[166:167], v[22:23]
    v_pk_fma_f32 v[164:165], v[12:13], v[12:13], v[164:165]
    v_pk_fma_f32 v[168:169], v[22:23], v[22:23], v[168:169]
    s_cmp_eq_u32 s45, 0
    s_cbranch_scc1 Lstats
    v_pk_add_f32 v[14:15], v[4:5], v[14:15] neg_lo:[0,1] neg_hi:[0,1]
    v_pk_add_f32 v[16:17], v[6:7], v[16:17] neg_lo:[0,1] neg_hi:[0,1]
    v_pk_add_f32 v[18:19], v[8:9], v[18:19] neg_lo:[0,1] neg_hi:[0,1]
    v_pk_add_f32 v[20:21], v[10:11], v[20:21] neg_lo:[0,1] neg_hi:[0,1]
    v_pk_add_f32 v[22:23], v[12:13], v[22:23] neg_lo:[0,1] neg_hi:[0,1]
    s_branch Lstats
Lhelp2:
    s_cmp_eq_u32 s26, 7
    s_cbranch_scc0 Lh7done
    v_mul_u32_u24 v3, 1536, v1
    v_mov_b32 v136, 0
    v_mov_b32 v137, 0
    s_mov_b64 exec, 0xff
    ds_write_b64 v3, v[136:137] offset:1280
    s_mov_b64 exec, -1
Lh7done:
    s_getreg_b32 s33, hwreg(HW_REG_XCC_ID, 0, 3)
    s_waitcnt vmcnt(0)
    v_add_u32 v132, 0x9e3779b8, v132
    v_and_b32 v134, -8, v132
    v_or_b32 v134, s33, v134
    s_cmp_eq_u32 s26, 7
    s_cbranch_scc0 Lh5
    v_mov_b32 v3, 27392
    ds_write_b32 v3, v132 offset:4
    s_lshl_b32 s33, s20, 5
    s_add_u32 s33, s33, s21
    s_lshl_b32 s33, s33, 7
    s_add_u32 s33, s33, 8192
    v_mov_b32 v3, 0
    s_mov_b64 exec, 1
    buffer_store_dword v134, v3, s[16:19], s33 offen sc1
    s_mov_b64 exec, -1
    s_branch Lsetup
Lh5:
    s_cmp_eq_u32 s26, 5
    s_cbranch_scc0 Lsetup
    s_cmp_eq_u32 s47, 0
    s_cbranch_scc1 Lsetup
    s_lshl_b32 s33, s20, 2
    s_lshr_b32 s49, s21, 3
    s_add_u32 s33, s33, s49
    s_lshl_b32 s33, s33, 7
    s_and_b32 s49, s21, 7
    s_lshl_b32 s49, s49, 2
    s_add_u32 s49, s33, s49
    v_mov_b32_e64 v3, s49
    s_mov_b64 exec, 1
    buffer_store_dword v132, v3, s[16:19], 0 offen offset:0 sc1
    s_mov_b64 exec, -1
    s_mov_b32 s33, 2592768
    buffer_store_dwordx4 v[212:215], v129, s[16:19], s33 offen sc1
    s_add_u32 s33, s33, 20480
    buffer_store_dwordx4 v[212:215], v129, s[16:19], s33 offen sc1
    s_add_u32 s33, s33, 20480
    buffer_store_dwordx4 v[212:215], v129, s[16:19], s33 offen sc1
    s_add_u32 s33, s33, 20480
    buffer_store_dwordx4 v[212:215], v129, s[16:19], s33 offen sc1
    s_add_u32 s33, s33, 20480
    buffer_store_dwordx4 v[212:215], v129, s[16:19], s33 offen sc1
    s_add_u32 s33, s33, 20480
    buffer_store_dwordx4 v[212:215], v129, s[16:19], s33 offen sc1
    s_add_u32 s33, s33, 20480
    buffer_store_dwordx4 v[212:215], v129, s[16:19], s33 offen sc1
    s_add_u32 s33, s33, 20480
    buffer_store_dwordx4 v[212:215], v129, s[16:19], s33 offen sc1
    s_branch Lsetup
Lloop:
    s_mov_b32 s32, 262144
    s_add_u32 s55, s31, 655360
    s_cmp_lg_u32 s29, 1
    s_cbranch_scc1 Lnofb
    v_lshrrev_b32 v3, 1, v1
    v_lshlrev_b32 v3, 7, v3
    v_and_b32 v228, 1, v1
    v_lshl_add_u32 v3, v228, 4, v3
    s_mov_b32 s66, 0x1f1f1f1f
    s_mov_b32 s67, 0x1f1f1f1f
    s_mov_b64 exec, s[66:67]
LflagB:
    buffer_load_dwordx4 v[136:139], v3, s[16:19], 0 offen offset:0 sc1
    s_waitcnt vmcnt(0)
    v_bitop3_b32 v136, v136, v137, v133 bitop3:0x7e
    v_bitop3_b32 v138, v138, v139, v133 bitop3:0x7e
    v_or_b32 v136, v136, v138
    v_cmp_ne_u32 vcc, 0, v136
    s_cbranch_vccz LflagBok
    s_sleep 2
    s_sub_u32 s32, s32, 1
    s_cmp_gt_i32 s32, 0
    s_cbranch_scc1 LflagB
LflagBok:
    s_mov_b64 exec, -1
Lnofb:
    s_waitcnt vmcnt(0)
    s_cmp_eq_u32 s47, 0
    s_cbranch_scc0 Lyf
    v_add_u32 v130, s29, v133
    s_mov_b64 exec, 1
Lgowait:
    buffer_load_dword v3, v135, s[16:19], 0 offen sc1
    s_waitcnt vmcnt(0)
    v_cmp_ne_u32 vcc, v3, v130
    s_cbranch_vccz Lgodone
    s_sub_u32 s32, s32, 1
    s_cmp_gt_i32 s32, 0
    s_cbranch_scc1 Lgowait
Lgodone:
    s_mov_b64 exec, -1
Lyf:
    s_cmp_ge_u32 s26, 6
    s_cbranch_scc1 Ltwo
Ly_p3:
    buffer_load_dwordx4 v[136:139], v89, s[16:19], s31 offen offset:0 sc1
    buffer_load_dwordx4 v[140:143], v89, s[16:19], s55 offen offset:0 sc1
    s_waitcnt vmcnt(1)
    v_max3_u32 v228, v136, v137, v138
    s_waitcnt vmcnt(0)
    v_max3_u32 v228, v228, v139, v140
    v_max3_u32 v228, v228, v141, v142
    v_max_u32 v3, v228, v143
    v_cmp_eq_u32 vcc, -1, v3
    s_cbranch_vccnz Ly_retry
Ly_done:
    s_mov_b64 exec, -1
    v_mfma_f32_16x16x32_f16 v[188:191], v[116:119], v[136:139], 0
    v_mfma_f32_16x16x32_f16 v[188:191], v[120:123], v[140:143], v[188:191]
Lone:
    s_add_u32 s31, s31, 1310720
    s_nop 3
    s_nop 2
    ds_write2st64_b64 v95, v[188:189], v[190:191] offset0:0 offset1:3
    s_cmp_eq_u32 s48, 0
    s_waitcnt lgkmcnt(0)
    s_barrier
    s_cbranch_scc1 Lidle
    ds_read_b32 v152, v72
    ds_read_b32 v153, v73
    ds_read_b64 v[154:155], v74
    ds_read_b64 v[156:157], v75
    ds_read_b64 v[158:159], v76
    ds_read_b64 v[160:161], v77
    s_cmp_eq_u32 s45, 0
    s_cbranch_scc0 Lswap
Lnoswap:
    s_cmp_eq_u32 s29, 4
    s_cbranch_scc1 Lfinal
    s_waitcnt lgkmcnt(4)
    v_pk_add_f32 v[4:5], v[4:5], v[152:153]
    v_pk_add_f32 v[14:15], v[14:15], v[152:153]
    v_pk_mul_f32 v[164:165], v[4:5], v[4:5]
    v_pk_mul_f32 v[168:169], v[14:15], v[14:15]
    s_waitcnt lgkmcnt(3)
    v_pk_add_f32 v[6:7], v[6:7], v[154:155]
    v_pk_add_f32 v[16:17], v[16:17], v[154:155]
    v_pk_add_f32 v[162:163], v[4:5], v[6:7]
    v_pk_add_f32 v[166:167], v[14:15], v[16:17]
    v_pk_fma_f32 v[164:165], v[6:7], v[6:7], v[164:165]
    v_pk_fma_f32 v[168:169], v[16:17], v[16:17], v[168:169]
    s_waitcnt lgkmcnt(2)
    v_pk_add_f32 v[8:9], v[8:9], v[156:157]
    v_pk_add_f32 v[18:19], v[18:19], v[156:157]
    v_pk_add_f32 v[162:163], v[162:163], v[8:9]
    v_pk_add_f32 v[166:167], v[166:167], v[18:19]
    v_pk_fma_f32 v[164:165], v[8:9], v[8:9], v[164:165]
    v_pk_fma_f32 v[168:169], v[18:19], v[18:19], v[168:169]
    s_waitcnt lgkmcnt(1)
    v_pk_add_f32 v[10:11], v[10:11], v[158:159]
    v_pk_add_f32 v[20:21], v[20:21], v[158:159]
    v_pk_add_f32 v[162:163], v[162:163], v[10:11]
    v_pk_add_f32 v[166:167], v[166:167], v[20:21]
    v_pk_fma_f32 v[164:165], v[10:11], v[10:11], v[164:165]
    v_pk_fma_f32 v[168:169], v[20:21], v[20:21], v[168:169]
    s_waitcnt lgkmcnt(0)
    v_pk_add_f32 v[12:13], v[12:13], v[160:161]
    v_pk_add_f32 v[22:23], v[22:23], v[160:161]
    v_pk_add_f32 v[162:163], v[162:163], v[12:13]
    v_pk_add_f32 v[166:167], v[166:167], v[22:23]
    v_pk_fma_f32 v[164:165], v[12:13], v[12:13], v[164:165]
    v_pk_fma_f32 v[168:169], v[22:23], v[22:23], v[168:169]
Lstats:
    v_add_f32 v162, v162, v163
    v_add_f32 v166, v166, v167
    v_add_f32 v164, v164, v165
    v_add_f32 v168, v168, v169
Lchain:
    v_permlane32_swap_b32 v162, v166
    s_nop 0
    v_permlane32_swap_b32 v164, v168
    v_add_f32 v162, v162, v166
    v_add_f32 v164, v164, v168
    s_nop 1
    v_permlane16_swap_b32 v162, v164
    v_add_f32 v162, v162, v164
    s_nop 1
    v_add_f32_dpp v162, v162, v162 row_ror:8 row_mask:0xf bank_mask:0xf
    s_nop 1
    v_add_f32_dpp v162, v162, v162 row_ror:4 row_mask:0xf bank_mask:0xf
    s_nop 1
    v_add_f32_dpp v162, v162, v162 row_ror:2 row_mask:0xf bank_mask:0xf
    s_nop 1
    v_add_f32_dpp v162, v162, v162 row_ror:1 row_mask:0xf bank_mask:0xf
    s_nop 1
    v_mul_f32_dpp v164, v162, v94 row_bcast:15 row_mask:0xa bank_mask:0xf
    v_fma_f32 v165, v164, v164, -s40
    v_fma_f32 v165, v162, s39, -v165
    v_max_f32 v165, s40, v165
    v_rsq_f32 v165, v165
    s_nop 0
    v_mul_f32 v164, v164, v165
    v_readlane_b32 s42, v165, 16
    v_readlane_b32 s44, v165, 48
    v_add_f32_dpp v166, v164, v164 row_bcast:31 row_mask:0x8 bank_mask:0xf
    s_add_u32 s42, s42, s36
    v_readlane_b32 s46, v166, 48
    s_xor_b32 s44, s44, s37
    s_cmp_eq_u32 s45, 0
    v_mov_b32 v168, s46
    v_pk_fma_f32 v[170:171], v[14:15], s[44:45], v[168:169] op_sel_hi:[1,0,0] neg_lo:[0,0,1] neg_hi:[0,0,1]
    v_pk_fma_f32 v[172:173], v[16:17], s[44:45], v[168:169] op_sel_hi:[1,0,0] neg_lo:[0,0,1] neg_hi:[0,0,1]
    v_pk_fma_f32 v[174:175], v[18:19], s[44:45], v[168:169] op_sel_hi:[1,0,0] neg_lo:[0,0,1] neg_hi:[0,0,1]
    v_pk_fma_f32 v[176:177], v[20:21], s[44:45], v[168:169] op_sel_hi:[1,0,0] neg_lo:[0,0,1] neg_hi:[0,0,1]
    v_pk_fma_f32 v[178:179], v[22:23], s[44:45], v[168:169] op_sel_hi:[1,0,0] neg_lo:[0,0,1] neg_hi:[0,0,1]
    v_pk_fma_f32 v[170:171], v[4:5], s[42:43], v[170:171] op_sel_hi:[1,0,1]
    v_pk_fma_f32 v[172:173], v[6:7], s[42:43], v[172:173] op_sel_hi:[1,0,1]
    v_pk_fma_f32 v[174:175], v[8:9], s[42:43], v[174:175] op_sel_hi:[1,0,1]
    v_pk_fma_f32 v[176:177], v[10:11], s[42:43], v[176:177] op_sel_hi:[1,0,1]
    v_pk_fma_f32 v[178:179], v[12:13], s[42:43], v[178:179] op_sel_hi:[1,0,1]
    v_cvt_pk_f16_f32 v180, v170, v174
    v_cvt_pk_f16_f32 v181, v178, v173
    v_cvt_pk_f16_f32 v182, v177, 0
    v_cvt_pk_f16_f32 v184, v172, v176
    v_cvt_pk_f16_f32 v185, v171, v175
    v_cvt_pk_f16_f32 v186, v179, 0
    v_mfma_f32_16x16x32_f16 v[188:191], v[180:183], v[24:27], 0
    v_mfma_f32_16x16x32_f16 v[192:195], v[180:183], v[28:31], 0
    v_mfma_f32_16x16x32_f16 v[196:199], v[184:187], v[24:27], 0
    v_mfma_f32_16x16x32_f16 v[200:203], v[184:187], v[28:31], 0
    s_nop 2
    s_nop 1
    v_cvt_pk_f16_f32 v228, v188, v189
    v_cvt_pk_f16_f32 v229, v190, v191
    v_cvt_pk_f16_f32 v230, v192, v193
    v_cvt_pk_f16_f32 v231, v194, v195
    v_pk_mul_f16 v204, v228, v64
    v_pk_mul_f16 v205, v229, v65
    v_pk_mul_f16 v206, v230, v64
    v_pk_mul_f16 v207, v231, v65
    v_pk_fma_f16 v204, v230, v66, v204
    v_pk_fma_f16 v205, v231, v67, v205
    v_pk_fma_f16 v206, v228, v66, v206 neg_lo:[1,0,0] neg_hi:[1,0,0]
    v_pk_fma_f16 v207, v229, v67, v207 neg_lo:[1,0,0] neg_hi:[1,0,0]
    s_nop 0
    s_nop 0
    v_mfma_f32_16x16x32_f16 v[212:215], v[32:35], v[204:207], 0
    v_cvt_pk_f16_f32 v232, v196, v197
    v_cvt_pk_f16_f32 v233, v198, v199
    v_cvt_pk_f16_f32 v234, v200, v201
    v_mfma_f32_16x16x32_f16 v[216:219], v[40:43], v[204:207], 0
    v_cvt_pk_f16_f32 v235, v202, v203
    v_pk_mul_f16 v208, v232, v68
    v_pk_mul_f16 v209, v233, v69
    v_mfma_f32_16x16x32_f16 v[220:223], v[48:51], v[204:207], 0
    v_pk_mul_f16 v210, v234, v68
    v_pk_mul_f16 v211, v235, v69
    v_pk_fma_f16 v208, v234, v70, v208
    v_mfma_f32_16x16x32_f16 v[224:227], v[56:59], v[204:207], 0
    v_pk_fma_f16 v209, v235, v71, v209
    v_pk_fma_f16 v210, v232, v70, v210 neg_lo:[1,0,0] neg_hi:[1,0,0]
    v_pk_fma_f16 v211, v233, v71, v211 neg_lo:[1,0,0] neg_hi:[1,0,0]
    s_nop 0
    s_nop 0
    v_mfma_f32_16x16x32_f16 v[212:215], v[36:39], v[208:211], v[212:215]
    v_mfma_f32_16x16x32_f16 v[216:219], v[44:47], v[208:211], v[216:219]
    v_mfma_f32_16x16x32_f16 v[220:223], v[52:55], v[208:211], v[220:223]
    v_mfma_f32_16x16x32_f16 v[224:227], v[60:63], v[208:211], v[224:227]
    s_cbranch_scc0 Lcwa
    s_nop 3
    v_cvt_pk_f16_f32 v228, v212, v213
    v_cvt_pk_f16_f32 v229, v214, v215
    ds_write_b32 v80, v228
    ds_write_b32 v84, v229
    v_cvt_pk_f16_f32 v230, v216, v217
    v_cvt_pk_f16_f32 v231, v218, v219
    ds_write_b32 v81, v230
    ds_write_b32 v85, v231
    v_cvt_pk_f16_f32 v232, v220, v221
    v_cvt_pk_f16_f32 v233, v222, v223
    ds_write_b32 v82, v232
    ds_write_b32 v86, v233
    v_cvt_pk_f16_f32 v234, v224, v225
    v_cvt_pk_f16_f32 v235, v226, v227
    ds_write_b32 v83, v234
    ds_write_b32 v87, v235
Lbar2:
    s_waitcnt lgkmcnt(0)
    s_barrier
    s_cmp_lt_u32 s26, 5
    s_cbranch_scc0 Lpubd
Lpub:
    ds_read2st64_b32 v[240:241], v90 offset0:48 offset1:51
    ds_read2st64_b32 v[242:243], v90 offset0:54 offset1:57
    s_cmp_eq_u32 s41, 0
    s_waitcnt lgkmcnt(1)
    v_and_or_b32 v240, v240, -2, s30
    v_and_or_b32 v241, v241, -2, s30
    s_waitcnt lgkmcnt(0)
    v_and_or_b32 v242, v242, -2, s30
    v_and_or_b32 v243, v243, -2, s30
    s_cbranch_scc1 Lpubg
    buffer_store_dwordx4 v[240:243], v88, s[16:19], 0 offen
Lpubd:
    s_cmp_lt_u32 s29, s41
    s_cbranch_scc1 Lfirst
    s_cmp_eq_u32 s41, 0
    s_cbranch_scc1 Lslow
    s_cmp_eq_u32 s47, 0
    s_cbranch_scc1 Lnext
Lpoll0:
    s_mov_b32 s32, 262144
Lpoll:
Lp_p3:
    buffer_load_dwordx4 v[136:139], v124, s[16:19], 0 offen offset:0 sc1
    s_waitcnt vmcnt(0)
    v_bitop3_b32 v228, v136, v137, s30 bitop3:0x7e
    v_bitop3_b32 v229, v138, v139, s30 bitop3:0x7e
    v_bitop3_b32 v3, v228, v229, 1 bitop3:0xa8
    v_cmp_ne_u32 vcc, 0, v3
    v_and_b32 v136, -2, v136
    v_and_b32 v137, -2, v137
    v_and_b32 v138, -2, v138
    v_and_b32 v139, -2, v139
    s_cbranch_vccnz Lp_retry
Lp_done:
    s_mov_b64 exec, -1
Lcfft:
    v_mfma_f32_16x16x32_f16 v[188:191], v[136:139], v[96:99], 0
    v_mfma_f32_16x16x32_f16 v[192:195], v[136:139], v[100:103], 0
    s_nop 3
    s_nop 2
    v_cvt_pk_f16_f32 v228, v188, v189
    v_cvt_pk_f16_f32 v229, v190, v191
    v_cvt_pk_f16_f32 v230, v192, v193
    v_cvt_pk_f16_f32 v231, v194, v195
    v_pk_mul_f16 v204, v228, v104
    v_pk_mul_f16 v205, v229, v105
    v_pk_mul_f16 v206, v230, v104
    v_pk_mul_f16 v207, v231, v105
    v_pk_fma_f16 v204, v230, v106, v204
    v_pk_fma_f16 v205, v231, v107, v205
    v_pk_fma_f16 v206, v228, v106, v206 neg_lo:[1,0,0] neg_hi:[1,0,0]
    v_pk_fma_f16 v207, v229, v107, v207 neg_lo:[1,0,0] neg_hi:[1,0,0]
    s_nop 1
    v_mfma_f32_16x16x32_f16 v[196:199], v[108:111], v[204:207], 0
    v_mfma_f32_16x16x32_f16 v[200:203], v[112:115], v[204:207], 0
    s_nop 7
    v_cvt_pk_f16_f32 v208, v196, v200
    v_cvt_pk_f16_f32 v209, v197, v201
    v_cvt_pk_f16_f32 v210, v198, v202
    v_cvt_pk_f16_f32 v211, v199, v203
    ds_write_b128 v126, v[208:211]
    s_waitcnt lgkmcnt(0)
    s_barrier
    ds_read_b64 v[224:225], v127
    ds_read_b64 v[226:227], v128
    s_waitcnt lgkmcnt(0)
    buffer_store_dwordx4 v[224:227], v129, s[16:19], s31 offen sc1
    s_cmp_ge_u32 s21, 12
    s_cbranch_scc1 Lnext
    s_add_u32 s33, s29, 1
    v_add_u32 v130, s33, v133
    s_mov_b64 exec, 1
    s_cmp_eq_u32 s41, 0
    s_cbranch_scc1 Lgog
    buffer_store_dword v130, v135, s[16:19], 0 offen
    s_mov_b64 exec, -1
    s_branch Lnext
Lgog:
    buffer_store_dword v130, v135, s[16:19], 0 offen sc1
    s_mov_b64 exec, -1
Lnext:
    s_add_u32 s29, s29, 1
    s_xor_b32 s30, s30, 1
    s_branch Lloop
Ly_retry:
    s_mov_b64 exec, vcc
    s_sub_u32 s32, s32, 1
    s_cmp_gt_i32 s32, 0
    s_cbranch_scc1 Ly_p3
    s_branch Ly_done
    s_nop 0
Ltwo:
Lz_p3:
    buffer_load_dwordx4 v[136:139], v89, s[16:19], s31 offen offset:0 sc1
    buffer_load_dwordx4 v[140:143], v89, s[16:19], s55 offen offset:0 sc1
    buffer_load_dwordx4 v[144:147], v89, s[16:19], s31 offen offset:512 sc1
    buffer_load_dwordx4 v[148:151], v89, s[16:19], s55 offen offset:512 sc1
    s_waitcnt vmcnt(3)
    v_max3_u32 v228, v136, v137, v138
    s_waitcnt vmcnt(2)
    v_max3_u32 v228, v228, v139, v140
    v_max3_u32 v228, v228, v141, v142
    s_waitcnt vmcnt(1)
    v_max3_u32 v228, v228, v143, v144
    v_max3_u32 v228, v228, v145, v146
    s_waitcnt vmcnt(0)
    v_max3_u32 v228, v228, v147, v148
    v_max3_u32 v228, v228, v149, v150
    v_max_u32 v3, v228, v151
    v_cmp_eq_u32 vcc, -1, v3
    s_cbranch_vccnz Lz_retry
Lz_done:
    s_mov_b64 exec, -1
    v_mfma_f32_16x16x32_f16 v[192:195], v[116:119], v[144:147], 0
    v_mfma_f32_16x16x32_f16 v[192:195], v[120:123], v[148:151], v[192:195]
    v_mfma_f32_16x16x32_f16 v[188:191], v[116:119], v[136:139], 0
    v_mfma_f32_16x16x32_f16 v[188:191], v[120:123], v[140:143], v[188:191]
    s_nop 5
    ds_write2st64_b64 v131, v[192:193], v[194:195] offset0:0 offset1:3
    s_branch Lone
    s_nop 0
Lswap:
    s_waitcnt lgkmcnt(0)
    s_mov_b32 exec_lo, 0
    v_swap_b32 v154, v155
    v_swap_b32 v156, v157
    v_swap_b32 v158, v159
    v_swap_b32 v160, v161
    s_mov_b32 exec_lo, -1
    s_cmp_eq_u32 s29, 4
    s_cbranch_scc1 Lswapf
    v_pk_add_f32 v[4:5], v[4:5], v[152:153]
    v_pk_add_f32 v[6:7], v[6:7], v[154:155]
    v_pk_add_f32 v[8:9], v[8:9], v[156:157]
    v_pk_add_f32 v[10:11], v[10:11], v[158:159]
    v_pk_add_f32 v[12:13], v[12:13], v[160:161]
    v_pk_mul_f32 v[164:165], v[4:5], v[4:5]
    v_pk_add_f32 v[162:163], v[4:5], v[6:7]
    v_pk_fma_f32 v[164:165], v[6:7], v[6:7], v[164:165]
    v_pk_add_f32 v[162:163], v[162:163], v[8:9]
    v_pk_fma_f32 v[164:165], v[8:9], v[8:9], v[164:165]
    v_pk_add_f32 v[162:163], v[162:163], v[10:11]
    v_pk_fma_f32 v[164:165], v[10:11], v[10:11], v[164:165]
    v_pk_add_f32 v[162:163], v[162:163], v[12:13]
    v_pk_fma_f32 v[164:165], v[12:13], v[12:13], v[164:165]
    v_add_f32 v166, v162, v163
    v_add_f32 v168, v164, v165
    v_add_f32 v162, v162, v163
    v_add_f32 v164, v164, v165
    s_branch Lchain
    s_nop 0
Lswapf:
    v_pk_add_f32 v[14:15], v[4:5], v[14:15] neg_lo:[0,1] neg_hi:[0,1]
    v_pk_add_f32 v[16:17], v[6:7], v[16:17] neg_lo:[0,1] neg_hi:[0,1]
    v_pk_add_f32 v[18:19], v[8:9], v[18:19] neg_lo:[0,1] neg_hi:[0,1]
    v_pk_add_f32 v[20:21], v[10:11], v[20:21] neg_lo:[0,1] neg_hi:[0,1]
    v_pk_add_f32 v[22:23], v[12:13], v[22:23] neg_lo:[0,1] neg_hi:[0,1]
    s_branch Lfinal
Lcwa:
    s_nop 3
    v_cvt_pk_f16_f32 v228, v212, v213
    ds_write_b32 v80, v228
    v_cvt_pk_f16_f32 v229, v216, v217
    ds_write_b32 v81, v229
    v_cvt_pk_f16_f32 v230, v220, v221
    ds_write_b32 v82, v230
    v_cvt_pk_f16_f32 v231, v224, v225
    ds_write_b32 v83, v231
    s_branch Lbar2
Lidle:
    s_cmp_eq_u32 s29, 4
    s_cbranch_scc1 Lexit
    s_cmp_eq_u32 s29, 3
    s_cbranch_scc1 Lbar2
    s_cmp_eq_u32 s26, 5
    s_cbranch_scc0 Lbar2
    s_cmp_eq_u32 s47, 0
    s_cbranch_scc1 Lbar2
    v_mov_b32 v212, -1
    v_mov_b32 v213, -1
    v_mov_b32 v214, -1
    v_mov_b32_e64 v215, -1
    s_add_u32 s33, s31, 1208320
    buffer_store_dwordx4 v[212:215], v129, s[16:19], s33 offen sc1
    s_add_u32 s33, s33, 20480
    buffer_store_dwordx4 v[212:215], v129, s[16:19], s33 offen sc1
    s_add_u32 s33, s33, 20480
    buffer_store_dwordx4 v[212:215], v129, s[16:19], s33 offen sc1
    s_add_u32 s33, s33, 20480
    buffer_store_dwordx4 v[212:215], v129, s[16:19], s33 offen sc1
    s_add_u32 s33, s33, 20480
    buffer_store_dwordx4 v[212:215], v129, s[16:19], s33 offen sc1
    s_add_u32 s33, s33, 20480
    buffer_store_dwordx4 v[212:215], v129, s[16:19], s33 offen sc1
    s_add_u32 s33, s33, 20480
    buffer_store_dwordx4 v[212:215], v129, s[16:19], s33 offen sc1
    s_add_u32 s33, s33, 20480
    buffer_store_dwordx4 v[212:215], v129, s[16:19], s33 offen sc1
    s_branch Lbar2
Lp_retry:
    s_mov_b64 exec, vcc
    s_sub_u32 s32, s32, 1
    s_cmp_gt_i32 s32, 0
    s_cbranch_scc1 Lp_p3
    s_branch Lp_done
Lz_retry:
    s_mov_b64 exec, vcc
    s_sub_u32 s32, s32, 1
    s_cmp_gt_i32 s32, 0
    s_cbranch_scc1 Lz_p3
    s_branch Lz_done
Lpubg:
    buffer_store_dwordx4 v[240:243], v88, s[16:19], 0 offen sc1
    s_branch Lpubd
Lslow:
    s_cmp_eq_u32 s29, 0
    s_cbranch_scc1 Lfirst
    s_cmp_eq_u32 s47, 0
    s_cbranch_scc1 Lnext
    s_mov_b32 s32, 262144
    s_mov_b64 exec, 1
Lp_p1:
    buffer_load_dword v130, v124, s[16:19], 0 offen sc1
    s_waitcnt vmcnt(0)
    v_bitop3_b32 v130, v130, 1, s30 bitop3:0x48
    v_cmp_ne_u32 vcc, 0, v130
    s_cbranch_vccz Lp_p2
    s_sleep 2
    s_sub_u32 s32, s32, 1
    s_cmp_gt_i32 s32, 0
    s_cbranch_scc1 Lp_p1
Lp_p2:
    s_mov_b64 exec, -1
    s_branch Lpoll
Lfirst:
    s_cmp_eq_u32 s48, 0
    s_cbranch_scc1 Lsetup_done
Lsetup:
    ds_read_b128 v[124:127], v2 offset:48128
    ds_read_b128 v[96:99], v2 offset:43008
    ds_read_b128 v[100:103], v2 offset:44032
    ds_read_b128 v[104:107], v2 offset:45056
    ds_read_b128 v[108:111], v2 offset:46080
    ds_read_b128 v[112:115], v2 offset:47104
    ds_read_b128 v[116:119], v2 offset:49152
    ds_read_b128 v[120:123], v2 offset:50176
    v_lshrrev_b32 v230, 3, v1
    s_lshl_b32 s33, s26, 3
    v_add_u32 v230, s33, v230
    v_sub_u32 v231, 128, v230
    v_cmp_eq_u32 vcc, 0, v230
    v_mov_b32 v232, 64
    s_nop 0
    v_cndmask_b32 v231, v231, v232, vcc
    v_and_b32 v232, 7, v1
    v_mul_u32_u24 v232, 1088, v232
    v_add_u32 v232, 18688, v232
    s_lshl_b32 s33, s21, 3
    s_add_u32 s33, s33, s26
    s_lshl_b32 s33, s33, 5
    s_waitcnt lgkmcnt(7)
    v_add_u32 v124, s33, v124
    v_and_b32 v233, 15, v230
    v_lshrrev_b32_e64 v234, 5, v230
    v_lshl_add_u32 v233, v234, 4, v233
    v_lshl_add_u32 v127, v233, 4, v232
    v_bfe_u32 v234, v230, 4, 1
    v_lshl_add_u32 v127, v234, 3, v127
    v_and_b32 v233, 15, v231
    v_lshrrev_b32 v234, 5, v231
    v_lshl_add_u32 v233, v234, 4, v233
    v_lshl_add_u32 v128, v233, 4, v232
    v_bfe_u32 v234, v231, 4, 1
    v_lshl_add_u32 v128, v234, 3, v128
    s_mul_i32 s33, s26, 1088
    s_add_u32 s33, s33, 18688
    v_add_u32 v126, s33, v2
    s_cmp_eq_u32 s48, 0
    s_cbranch_scc1 Lbar2
Lsetup_done:
    s_cmp_eq_u32 s26, 6
    s_cbranch_scc0 Lnof7
    v_lshlrev_b32 v3, 7, v1
    s_lshl_b32 s33, s20, 12
    s_add_u32 s33, s33, 8192
    s_mov_b32 s32, 262144
    s_mov_b32 exec_hi, 0
Lflag:
    buffer_load_dword v136, v3, s[16:19], s33 offen sc1
    s_waitcnt vmcnt(0)
    v_xor_b32 v136, v136, v134
    v_cmp_lt_u32 vcc, 7, v136
    s_cbranch_vccz Lflagok
    s_sub_u32 s32, s32, 1
    s_cmp_gt_i32 s32, 0
    s_cbranch_scc1 Lflag
Lflagok:
    v_cmp_ne_u32 vcc, 0, v136
    s_mov_b64 exec, -1
    s_cmp_eq_u32 vcc_lo, 0
    s_cselect_b32 s33, 1, 0
    v_mov_b32 v136, s33
    v_mov_b32 v3, 27392
    ds_write_b32 v3, v136
Lnof7:
    s_waitcnt vmcnt(0) lgkmcnt(0)
    s_barrier
    v_mov_b32 v3, 27392
    ds_read_b32 v133, v3 offset:4
    ds_read_b32 v3, v3
    s_waitcnt lgkmcnt(0)
    v_readfirstlane_b32 s41, v3
    s_nop 0
    s_cmp_eq_u32 s41, 0
    s_cbranch_scc0 Lmode1
    s_cmp_lt_u32 s26, 5
    s_cbranch_scc0 Lmode1
    buffer_store_dwordx4 v[240:243], v88, s[16:19], 0 offen sc1
    s_waitcnt vmcnt(0)
Lmode1:
    s_cmp_eq_u32 s47, 0
    s_cbranch_scc1 Lnext
    s_branch Lpoll0
Lfinal:
    s_waitcnt lgkmcnt(4)
    v_pk_add_f32 v[4:5], v[4:5], v[152:153]
    v_pk_add_f32 v[14:15], v[14:15], v[152:153]
    v_cvt_pk_bf16_f32 v170, v4, v5
    v_cvt_pk_bf16_f32 v175, v14, v15
    ds_write_b16 v91, v170 offset:0
    ds_write_b16_d16_hi v91, v170 offset:160
    ds_write_b16 v93, v175
    ds_write_b16_d16_hi v92, v175 offset:128
    s_waitcnt lgkmcnt(7)
    s_nop 0
    v_pk_add_f32 v[6:7], v[6:7], v[154:155]
    v_pk_add_f32 v[16:17], v[16:17], v[154:155]
    v_cvt_pk_bf16_f32 v171, v6, v7
    v_cvt_pk_bf16_f32 v176, v16, v17
    ds_write_b16 v91, v171 offset:32
    ds_write_b16_d16_hi v91, v171 offset:192
    ds_write_b16 v92, v176 offset:256
    ds_write_b16_d16_hi v92, v176 offset:96
    s_waitcnt lgkmcnt(10)
    s_nop 0
    v_pk_add_f32 v[8:9], v[8:9], v[156:157]
    v_pk_add_f32 v[18:19], v[18:19], v[156:157]
    v_cvt_pk_bf16_f32 v172, v8, v9
    v_cvt_pk_bf16_f32 v177, v18, v19
    ds_write_b16 v91, v172 offset:64
    ds_write_b16_d16_hi v91, v172 offset:224
    ds_write_b16 v92, v177 offset:224
    ds_write_b16_d16_hi v92, v177 offset:64
    s_waitcnt lgkmcnt(13)
    s_nop 0
    v_pk_add_f32 v[10:11], v[10:11], v[158:159]
    v_pk_add_f32 v[20:21], v[20:21], v[158:159]
    v_cvt_pk_bf16_f32 v173, v10, v11
    v_cvt_pk_bf16_f32 v178, v20, v21
    ds_write_b16 v91, v173 offset:96
    ds_write_b16_d16_hi v91, v173 offset:256
    ds_write_b16 v92, v178 offset:192
    ds_write_b16_d16_hi v92, v178 offset:32
    s_waitcnt lgkmcnt(15)
    s_nop 0
    v_pk_add_f32 v[12:13], v[12:13], v[160:161]
    v_pk_add_f32 v[22:23], v[22:23], v[160:161]
    v_cvt_pk_bf16_f32 v174, v12, v13
    v_cvt_pk_bf16_f32 v179, v22, v23
    ds_write_b16 v91, v174 offset:128
    ds_write_b16_d16_hi v91, v174 offset:288
    ds_write_b16 v92, v179 offset:160
    ds_write_b16_d16_hi v92, v179 offset:0
    v_add_u32 v3, s54, v2
    s_waitcnt lgkmcnt(0)
    ds_read_b128 v[188:191], v3
    ds_read_b128 v[192:195], v3 offset:1280
    ds_read_b128 v[196:199], v3 offset:1024
    ds_read_b128 v[200:203], v3 offset:2304
    s_waitcnt lgkmcnt(3)
    buffer_store_dwordx4 v[188:191], v2, s[12:15], s50 offen
    s_waitcnt lgkmcnt(2)
    buffer_store_dwordx4 v[192:195], v2, s[12:15], s51 offen
    s_mov_b64 exec, 0xffff
    s_waitcnt lgkmcnt(0)
    buffer_store_dwordx4 v[196:199], v2, s[12:15], s50 offen offset:1024
    buffer_store_dwordx4 v[200:203], v2, s[12:15], s51 offen offset:1024
    s_branch Lend
Lexit:
    s_cmp_lg_u32 s2, 0
    s_cbranch_scc1 Lend
    s_cmp_lg_u32 s26, 7
    s_cbranch_scc1 Lend
    v_mov_b32 v3, 4096
    s_mov_b64 exec, 1
    buffer_store_dword v132, v3, s[16:19], 0 offen sc1
Lend:
    s_endpgm
.p2align 8
.type fft_tables,@object
fft_tables:
.long 0x34003400,0x34003400,0x3400,0x0,0x339c3400,0x30b43279,0x2cf2,0x0
.long 0x32793400,0xacf22cf2,0xb279,0x0,0x30b43400,0xb39cacf2,0xb279,0x0
.long 0x2cf23400,0xb279b279,0x2cf2,0x0,0x3400,0x8000b400,0x3400,0x0
.long 0xacf23400,0x3279b279,0x2cf2,0x0,0xb0b43400,0x339cacf2,0xb279,0x0
.long 0xb2793400,0x2cf22cf2,0xb279,0x0,0xb39c3400,0xb0b43279,0x2cf2,0x0
.long 0xb4003400,0xb4003400,0x3400,0x0,0x0,0x0,0x0,0x0
.long 0x0,0x0,0x0,0x0,0x0,0x0,0x0,0x0
.long 0x0,0x0,0x0,0x0,0x0,0x0,0x0,0x0
.long 0x34003400,0x34003400,0x3400,0x0,0xacf20000,0xb279b0b4,0xb39c,0x0
.long 0xb279b400,0x2cf2acf2,0x3279,0x0,0x32798000,0x2cf2339c,0xb0b4,0x0
.long 0x2cf23400,0xb279b279,0x2cf2,0x0,0xb4000000,0x34008000,0x0,0x0
.long 0x2cf2b400,0xb2793279,0xacf2,0x0,0x32798000,0x2cf2b39c,0x30b4,0x0
.long 0xb2793400,0x2cf22cf2,0xb279,0x0,0xacf20000,0xb27930b4,0x339c,0x0
.long 0x3400b400,0x3400b400,0xb400,0x0,0x0,0x0,0x0,0x0
.long 0x0,0x0,0x0,0x0,0x0,0x0,0x0,0x0
.long 0x0,0x0,0x0,0x0,0x0,0x0,0x0,0x0
.long 0x34003400,0x34003400,0x3400,0x0,0xb39cb400,0xb0b4b279,0xacf2,0x0
.long 0x32793400,0xacf22cf2,0xb279,0x0,0xb0b4b400,0x339c2cf2,0x3279,0x0
.long 0x2cf23400,0xb279b279,0x2cf2,0x0,0x8000b400,0x3400,0xb400,0x0
.long 0xacf23400,0x3279b279,0x2cf2,0x0,0x30b4b400,0xb39c2cf2,0x3279,0x0
.long 0xb2793400,0x2cf22cf2,0xb279,0x0,0x339cb400,0x30b4b279,0xacf2,0x0
.long 0xb4003400,0xb4003400,0x3400,0x0,0x0,0x0,0x0,0x0
.long 0x0,0x0,0x0,0x0,0x0,0x0,0x0,0x0
.long 0x0,0x0,0x0,0x0,0x0,0x0,0x0,0x0
.long 0x34003400,0x34003400,0x3400,0x0,0x2cf28000,0x327930b4,0x339c,0x0
.long 0xb279b400,0x2cf2acf2,0x3279,0x0,0xb2790000,0xacf2b39c,0x30b4,0x0
.long 0x2cf23400,0xb279b279,0x2cf2,0x0,0x34008000,0xb4000000,0x8000,0x0
.long 0x2cf2b400,0xb2793279,0xacf2,0x0,0xb2790000,0xacf2339c,0xb0b4,0x0
.long 0xb2793400,0x2cf22cf2,0xb279,0x0,0x2cf28000,0x3279b0b4,0xb39c,0x0
.long 0x3400b400,0x3400b400,0xb400,0x0,0x0,0x0,0x0,0x0
.long 0x0,0x0,0x0,0x0,0x0,0x0,0x0,0x0
.long 0x0,0x0,0x0,0x0,0x0,0x0,0x0,0x0
.long 0x80008000,0x80008000,0x8000,0x0,0xacf28000,0xb279b0b4,0xb39c,0x0
.long 0xb0b48000,0xb39cb39c,0xb0b4,0x0,0xb2798000,0xacf2b39c,0x30b4,0x0
.long 0xb39c8000,0x30b4b0b4,0x339c,0x0,0xb4008000,0x34008000,0x8000,0x0
.long 0xb39c8000,0x30b430b4,0xb39c,0x0,0xb2798000,0xacf2339c,0xb0b4,0x0
.long 0xb0b48000,0xb39c339c,0x30b4,0x0,0xacf28000,0xb27930b4,0x339c,0x0
.long 0x80008000,0x80008000,0x8000,0x0,0x0,0x0,0x0,0x0
.long 0x0,0x0,0x0,0x0,0x0,0x0,0x0,0x0
.long 0x0,0x0,0x0,0x0,0x0,0x0,0x0,0x0
.long 0x80008000,0x80008000,0x8000,0x0,0xb39cb400,0xb0b4b279,0xacf2,0x0
.long 0x30b48000,0x339c339c,0x30b4,0x0,0x30b43400,0xb39cacf2,0xb279,0x0
.long 0xb39c8000,0x30b4b0b4,0x339c,0x0,0x8000b400,0x80003400,0xb400,0x0
.long 0x339c8000,0xb0b4b0b4,0x339c,0x0,0xb0b43400,0x339cacf2,0xb279,0x0
.long 0xb0b48000,0xb39c339c,0x30b4,0x0,0x339cb400,0x30b4b279,0xacf2,0x0
.long 0x80008000,0x80008000,0x8000,0x0,0x0,0x0,0x0,0x0
.long 0x0,0x0,0x0,0x0,0x0,0x0,0x0,0x0
.long 0x0,0x0,0x0,0x0,0x0,0x0,0x0,0x0
.long 0x80008000,0x80008000,0x8000,0x0,0x2cf28000,0x327930b4,0x339c,0x0
.long 0xb0b48000,0xb39cb39c,0xb0b4,0x0,0x32798000,0x2cf2339c,0xb0b4,0x0
.long 0xb39c8000,0x30b4b0b4,0x339c,0x0,0x34008000,0xb4008000,0x8000,0x0
.long 0xb39c8000,0x30b430b4,0xb39c,0x0,0x32798000,0x2cf2b39c,0x30b4,0x0
.long 0xb0b48000,0xb39c339c,0x30b4,0x0,0x2cf28000,0x3279b0b4,0xb39c,0x0
.long 0x80008000,0x80008000,0x8000,0x0,0x0,0x0,0x0,0x0
.long 0x0,0x0,0x0,0x0,0x0,0x0,0x0,0x0
.long 0x0,0x0,0x0,0x0,0x0,0x0,0x0,0x0
.long 0x80008000,0x80008000,0x8000,0x0,0x339c3400,0x30b43279,0x2cf2,0x0
.long 0x30b48000,0x339c339c,0x30b4,0x0,0xb0b4b400,0x339c2cf2,0x3279,0x0
.long 0xb39c8000,0x30b4b0b4,0x339c,0x0,0x80003400,0x8000b400,0x3400,0x0
.long 0x339c8000,0xb0b4b0b4,0x339c,0x0,0x30b4b400,0xb39c2cf2,0x3279,0x0
.long 0xb0b48000,0xb39c339c,0x30b4,0x0,0xb39c3400,0xb0b43279,0x2cf2,0x0
.long 0x80008000,0x80008000,0x8000,0x0,0x0,0x0,0x0,0x0
.long 0x0,0x0,0x0,0x0,0x0,0x0,0x0,0x0
.long 0x0,0x0,0x0,0x0,0x0,0x0,0x0,0x0
.long 0x32d43000,0x32d43400,0xada8b000,0x2da88000,0x2da83000,0xada80000,0x32d43000,0x32d43400
.long 0x28b03000,0x28b00000,0x2da83000,0xada80000,0x2da83000,0xada80000,0xa8b0b000,0xa8b00000
.long 0x33403000,0x301b3364,0xa9c5b000,0x32252e1f,0x29c53000,0xb225ae1f,0x33403000,0x301b3364
.long 0x24c73000,0x2d170000,0x2e013000,0xaace0000,0x2e013000,0xaace0000,0xa4c7b000,0xad170000
.long 0x33643000,0x31a8,0x8000b000,0x336431a8,0x3000,0xb364b1a8,0x33643000,0x31a8
.long 0x3000,0x2e1f0000,0x2e1f3000,0x80000000,0x2e1f3000,0x80000000,0xb000,0xae1f0000
.long 0x33403000,0xb01b2e1f,0x29c5b000,0x32253364,0xa9c53000,0xb225b364,0x33403000,0xb01b2e1f
.long 0xa4c73000,0x2d178000,0x2e013000,0x2ace0000,0x2e013000,0x2ace0000,0x24c7b000,0xad170000
.long 0x28b03000,0x28b00000,0x2da83000,0xada80000,0xada8b000,0x2da88000,0x28b03000,0x28b00000
.long 0x32d43000,0x32d43400,0xada8b000,0x2da88000,0xada8b000,0x2da88000,0xb2d4b000,0xb2d4b400
.long 0xaace0000,0x2e018000,0x2d1731a8,0x24c70000,0xad17b1a8,0xa4c78000,0xaace0000,0x2e018000
.long 0x322531a8,0xa9c52e1f,0x301b8000,0x33403364,0x301b8000,0x33403364,0xb225b1a8,0x29c5ae1f
.long 0xae1fb000,0x0,0x3000,0x2e1f0000,0x8000b000,0xae1f0000,0xae1fb000,0x0
.long 0x3000,0xb364b1a8,0x33643000,0x31a8,0x33643000,0x31a8,0x8000b000,0x336431a8
.long 0xaaceb1a8,0xae018000,0xad170000,0x24c70000,0x2d178000,0xa4c78000,0xaaceb1a8,0xae018000
.long 0xb2250000,0xa9c5b364,0x301b31a8,0xb340ae1f,0x301b31a8,0xb340ae1f,0x32258000,0x29c53364
.long 0x32d43000,0x32d43400,0xada8b000,0x2da88000,0x2da83000,0xada80000,0x32d43000,0x32d43400
.long 0x28b03000,0x28b00000,0x2da83000,0xada80000,0x2da83000,0xada80000,0xa8b0b000,0xa8b00000
.long 0x29c53000,0xb225ae1f,0x33403000,0x301b3364,0xb340b000,0xb01bb364,0x29c53000,0xb225ae1f
.long 0xae01b000,0x2ace8000,0x24c73000,0x2d178000,0x24c73000,0x2d178000,0x2e013000,0xaace0000
.long 0xb364b000,0x8000b1a8,0x3000,0xb364b1a8,0x8000b000,0x336431a8,0xb364b000,0x8000b1a8
.long 0x8000b000,0xae1f0000,0xae1fb000,0x8000,0xae1fb000,0x8000,0x3000,0x2e1f0000
.long 0x29c5b000,0x32253364,0xb340b000,0x301bae1f,0x33403000,0xb01b2e1f,0x29c5b000,0x32253364
.long 0x2e013000,0x2ace8000,0x24c7b000,0xad178000,0x24c7b000,0xad178000,0xae01b000,0xaace0000
.long 0x28b03000,0x28b00000,0x2da83000,0xada80000,0xada8b000,0x2da88000,0x28b03000,0x28b00000
.long 0x32d43000,0x32d43400,0xada8b000,0x2da88000,0xada8b000,0x2da88000,0xb2d4b000,0xb2d4b400
.long 0xad17b1a8,0xa4c70000,0xaace0000,0x2e010000,0x2ace8000,0xae018000,0xad17b1a8,0xa4c70000
.long 0xb01b0000,0xb340b364,0x322531a8,0xa9c52e1f,0x322531a8,0xa9c52e1f,0x301b8000,0x33403364
.long 0x2e1f3000,0x80008000,0xb000,0xae1f0000,0x80003000,0x2e1f0000,0x2e1f3000,0x80008000
.long 0xb000,0x336431a8,0xb364b000,0x8000b1a8,0xb364b000,0x8000b1a8,0x80003000,0xb364b1a8
.long 0xad170000,0x24c70000,0x2ace31a8,0x2e010000,0xaaceb1a8,0xae010000,0xad170000,0x24c70000
.long 0x301b31a8,0xb340ae1f,0x32258000,0x29c53364,0x32258000,0x29c53364,0xb01bb1a8,0x33402e1f
.long 0x32d43000,0x32d43400,0xada8b000,0x2da88000,0x2da83000,0xada80000,0x32d43000,0x32d43400
.long 0x28b03000,0x28b00000,0x2da83000,0xada80000,0x2da83000,0xada80000,0xa8b0b000,0xa8b00000
.long 0xb340b000,0xb01bb364,0x29c53000,0xb225ae1f,0xa9c5b000,0x32252e1f,0xb340b000,0xb01bb364
.long 0xa4c7b000,0xad178000,0xae01b000,0x2ace0000,0xae01b000,0x2ace0000,0x24c73000,0x2d170000
.long 0x33643000,0x31a8,0x8000b000,0x336431a8,0x3000,0xb364b1a8,0x33643000,0x31a8
.long 0x3000,0x2e1f0000,0x2e1f3000,0x80000000,0x2e1f3000,0x80000000,0xb000,0xae1f0000
.long 0xb340b000,0x301bae1f,0xa9c53000,0xb225b364,0x29c5b000,0x32253364,0xb340b000,0x301bae1f
.long 0x24c7b000,0xad170000,0xae01b000,0xaace0000,0xae01b000,0xaace0000,0xa4c73000,0x2d178000
.long 0x28b03000,0x28b00000,0x2da83000,0xada80000,0xada8b000,0x2da88000,0x28b03000,0x28b00000
.long 0x32d43000,0x32d43400,0xada8b000,0x2da88000,0xada8b000,0x2da88000,0xb2d4b000,0xb2d4b400
.long 0x2ace8000,0xae018000,0xad17b1a8,0xa4c70000,0x2d1731a8,0x24c78000,0x2ace8000,0xae018000
.long 0xb225b1a8,0x29c5ae1f,0xb01b0000,0xb340b364,0xb01b0000,0xb340b364,0x322531a8,0xa9c52e1f
.long 0xae1fb000,0x0,0x3000,0x2e1f0000,0x8000b000,0xae1f0000,0xae1fb000,0x0
.long 0x3000,0xb364b1a8,0x33643000,0x31a8,0x33643000,0x31a8,0x8000b000,0x336431a8
.long 0x2ace31a8,0x2e010000,0x2d178000,0xa4c78000,0xad170000,0x24c70000,0x2ace31a8,0x2e010000
.long 0x32258000,0x29c53364,0xb01bb1a8,0x33402e1f,0xb01bb1a8,0x33402e1f,0xb2250000,0xa9c5b364
.long 0x32d43000,0x32d43400,0xada8b000,0x2da88000,0x2da83000,0xada80000,0x32d43000,0x32d43400
.long 0x28b03000,0x28b00000,0x2da83000,0xada80000,0x2da83000,0xada80000,0xa8b0b000,0xa8b00000
.long 0xa9c5b000,0x32252e1f,0xb340b000,0xb01bb364,0x33403000,0x301b3364,0xa9c5b000,0x32252e1f
.long 0x2e013000,0xaace0000,0xa4c7b000,0xad170000,0xa4c7b000,0xad170000,0xae01b000,0x2ace8000
.long 0xb364b000,0x8000b1a8,0x3000,0xb364b1a8,0x8000b000,0x336431a8,0xb364b000,0x8000b1a8
.long 0x8000b000,0xae1f0000,0xae1fb000,0x8000,0xae1fb000,0x8000,0x3000,0x2e1f0000
.long 0xa9c53000,0xb225b364,0x33403000,0xb01b2e1f,0xb340b000,0x301bae1f,0xa9c53000,0xb225b364
.long 0xae01b000,0xaace8000,0xa4c73000,0x2d178000,0xa4c73000,0x2d178000,0x2e013000,0x2ace0000
.long 0x28b03000,0x28b00000,0x2da83000,0xada80000,0xada8b000,0x2da88000,0x28b03000,0x28b00000
.long 0x32d43000,0x32d43400,0xada8b000,0x2da88000,0xada8b000,0x2da88000,0xb2d4b000,0xb2d4b400
.long 0x2d1731a8,0x24c70000,0x2ace8000,0xae018000,0xaace0000,0x2e010000,0x2d1731a8,0x24c70000
.long 0x301b8000,0x33403364,0xb225b1a8,0x29c5ae1f,0xb225b1a8,0x29c5ae1f,0xb01b0000,0xb340b364
.long 0x2e1f3000,0x80008000,0xb000,0xae1f0000,0x80003000,0x2e1f0000,0x2e1f3000,0x80008000
.long 0xb000,0x336431a8,0xb364b000,0x8000b1a8,0xb364b000,0x8000b1a8,0x80003000,0xb364b1a8
.long 0x2d178000,0xa4c70000,0xaaceb1a8,0xae010000,0x2ace31a8,0x2e018000,0x2d178000,0xa4c70000
.long 0xb01bb1a8,0x33402e1f,0xb2250000,0xa9c5b364,0xb2250000,0xa9c5b364,0x301b31a8,0xb340ae1f
.long 0x2da83000,0x2da8b400,0x32d4b000,0xb2d40000,0xb2d43000,0x32d48000,0x2da83000,0x2da8b400
.long 0xada83000,0xada80000,0x28b03000,0xa8b08000,0x28b03000,0xa8b08000,0x2da8b000,0x2da80000
.long 0x29c53000,0x3225b364,0x3340b000,0xb01bae1f,0xb3403000,0x301b2e1f,0x29c53000,0x3225b364
.long 0xae013000,0xaace8000,0x24c73000,0xad170000,0x24c73000,0xad170000,0x2e01b000,0x2ace0000
.long 0x3000,0x3364b1a8,0x3364b000,0x8000b1a8,0xb3643000,0x31a8,0x3000,0x3364b1a8
.long 0xae1f3000,0x80000000,0x3000,0xae1f8000,0x3000,0xae1f8000,0x2e1fb000,0x0
.long 0xa9c53000,0x3225ae1f,0x3340b000,0x301bb364,0xb3403000,0xb01b3364,0xa9c53000,0x3225ae1f
.long 0xae013000,0x2ace0000,0xa4c73000,0xad170000,0xa4c73000,0xad170000,0x2e01b000,0xaace8000
.long 0xada83000,0xada80000,0x28b03000,0xa8b00000,0xa8b0b000,0x28b08000,0xada83000,0xada80000
.long 0x2da83000,0x2da8b400,0x32d4b000,0xb2d40000,0x32d4b000,0xb2d40000,0xada8b000,0xada83400
.long 0xad170000,0x24c78000,0xaace31a8,0xae010000,0x2aceb1a8,0x2e018000,0xad170000,0x24c78000
.long 0xb01b31a8,0x3340ae1f,0x32258000,0x29c5b364,0x32258000,0x29c5b364,0x301bb1a8,0xb3402e1f
.long 0x8000b000,0x2e1f8000,0xae1f3000,0x0,0x2e1fb000,0x0,0x8000b000,0x2e1f8000
.long 0xb3643000,0x31a8,0x3000,0x3364b1a8,0x3000,0x3364b1a8,0x3364b000,0x8000b1a8
.long 0x2d17b1a8,0x24c70000,0xaace0000,0x2e018000,0x2ace8000,0xae010000,0x2d17b1a8,0x24c70000
.long 0xb01b0000,0xb3403364,0xb22531a8,0x29c52e1f,0xb22531a8,0x29c52e1f,0x301b8000,0x3340b364
.long 0x2da83000,0x2da8b400,0x32d4b000,0xb2d40000,0xb2d43000,0x32d48000,0x2da83000,0x2da8b400
.long 0xada83000,0xada80000,0x28b03000,0xa8b08000,0x28b03000,0xa8b08000,0x2da8b000,0x2da80000
.long 0xb3403000,0x301b2e1f,0x29c53000,0x3225b364,0xa9c5b000,0xb2253364,0xb3403000,0x301b2e1f
.long 0xa4c7b000,0x2d170000,0xae013000,0xaace0000,0xae013000,0xaace0000,0x24c73000,0xad178000
.long 0x8000b000,0xb36431a8,0xb3643000,0x800031a8,0x3364b000,0xb1a8,0x8000b000,0xb36431a8
.long 0x2e1fb000,0x80000000,0x8000b000,0x2e1f0000,0x8000b000,0x2e1f0000,0xae1f3000,0x0
.long 0x3340b000,0x301bb364,0x29c5b000,0xb2252e1f,0xa9c53000,0x3225ae1f,0x3340b000,0x301bb364
.long 0xa4c73000,0xad178000,0x2e01b000,0xaace8000,0x2e01b000,0xaace8000,0x24c7b000,0x2d170000
.long 0xada83000,0xada80000,0x28b03000,0xa8b00000,0xa8b0b000,0x28b08000,0xada83000,0xada80000
.long 0x2da83000,0x2da8b400,0x32d4b000,0xb2d40000,0x32d4b000,0xb2d40000,0xada8b000,0xada83400
.long 0x2aceb1a8,0x2e010000,0xad170000,0x24c78000,0x2d178000,0xa4c70000,0x2aceb1a8,0x2e010000
.long 0xb2250000,0xa9c53364,0xb01b31a8,0x3340ae1f,0xb01b31a8,0x3340ae1f,0x32258000,0x29c5b364
.long 0x3000,0xae1f0000,0x2e1fb000,0x0,0xae1f3000,0x80000000,0x3000,0xae1f0000
.long 0x3364b000,0x8000b1a8,0x8000b000,0xb36431a8,0x8000b000,0xb36431a8,0xb3643000,0x31a8
.long 0xaace0000,0x2e010000,0xad1731a8,0xa4c70000,0x2d17b1a8,0x24c78000,0xaace0000,0x2e010000
.long 0xb22531a8,0x29c52e1f,0x301b8000,0x3340b364,0x301b8000,0x3340b364,0x3225b1a8,0xa9c5ae1f
.long 0x2da83000,0x2da8b400,0x32d4b000,0xb2d40000,0xb2d43000,0x32d48000,0x2da83000,0x2da8b400
.long 0xada83000,0xada80000,0x28b03000,0xa8b08000,0x28b03000,0xa8b08000,0x2da8b000,0x2da80000
.long 0xa9c5b000,0xb2253364,0xb3403000,0x301b2e1f,0x3340b000,0xb01bae1f,0xa9c5b000,0xb2253364
.long 0x2e01b000,0x2ace0000,0xa4c7b000,0x2d170000,0xa4c7b000,0x2d170000,0xae013000,0xaace0000
.long 0x3000,0x3364b1a8,0x3364b000,0x8000b1a8,0xb3643000,0x31a8,0x3000,0x3364b1a8
.long 0xae1f3000,0x80000000,0x3000,0xae1f8000,0x3000,0xae1f8000,0x2e1fb000,0x0
.long 0x29c5b000,0xb2252e1f,0xb3403000,0xb01b3364,0x3340b000,0x301bb364,0x29c5b000,0xb2252e1f
.long 0x2e01b000,0xaace8000,0x24c7b000,0x2d170000,0x24c7b000,0x2d170000,0xae013000,0x2ace0000
.long 0xada83000,0xada80000,0x28b03000,0xa8b00000,0xa8b0b000,0x28b08000,0xada83000,0xada80000
.long 0x2da83000,0x2da8b400,0x32d4b000,0xb2d40000,0x32d4b000,0xb2d40000,0xada8b000,0xada83400
.long 0x2d178000,0xa4c78000,0x2aceb1a8,0x2e010000,0xaace31a8,0xae018000,0x2d178000,0xa4c78000
.long 0x301bb1a8,0xb3402e1f,0xb2250000,0xa9c53364,0xb2250000,0xa9c53364,0xb01b31a8,0x3340ae1f
.long 0x8000b000,0x2e1f8000,0xae1f3000,0x0,0x2e1fb000,0x0,0x8000b000,0x2e1f8000
.long 0xb3643000,0x31a8,0x3000,0x3364b1a8,0x3000,0x3364b1a8,0x3364b000,0x8000b1a8
.long 0xad1731a8,0xa4c78000,0x2ace8000,0xae010000,0xaace0000,0x2e018000,0xad1731a8,0xa4c78000
.long 0x301b8000,0x3340b364,0x3225b1a8,0xa9c5ae1f,0x3225b1a8,0xa9c5ae1f,0xb01b0000,0xb3403364
.long 0x2da83000,0x2da8b400,0x32d4b000,0xb2d40000,0xb2d43000,0x32d48000,0x2da83000,0x2da8b400
.long 0xada83000,0xada80000,0x28b03000,0xa8b08000,0x28b03000,0xa8b08000,0x2da8b000,0x2da80000
.long 0x3340b000,0xb01bae1f,0xa9c5b000,0xb2253364,0x29c53000,0x3225b364,0x3340b000,0xb01bae1f
.long 0x24c73000,0xad178000,0x2e01b000,0x2ace8000,0x2e01b000,0x2ace8000,0xa4c7b000,0x2d170000
.long 0x8000b000,0xb36431a8,0xb3643000,0x800031a8,0x3364b000,0xb1a8,0x8000b000,0xb36431a8
.long 0x2e1fb000,0x80000000,0x8000b000,0x2e1f0000,0x8000b000,0x2e1f0000,0xae1f3000,0x0
.long 0xb3403000,0xb01b3364,0xa9c53000,0x3225ae1f,0x29c5b000,0xb2252e1f,0xb3403000,0xb01b3364
.long 0x24c7b000,0x2d178000,0xae013000,0x2ace8000,0xae013000,0x2ace8000,0xa4c73000,0xad170000
.long 0xada83000,0xada80000,0x28b03000,0xa8b00000,0xa8b0b000,0x28b08000,0xada83000,0xada80000
.long 0x2da83000,0x2da8b400,0x32d4b000,0xb2d40000,0x32d4b000,0xb2d40000,0xada8b000,0xada83400
.long 0xaace31a8,0xae010000,0x2d178000,0xa4c70000,0xad170000,0x24c78000,0xaace31a8,0xae010000
.long 0x32258000,0x29c5b364,0x301bb1a8,0xb3402e1f,0x301bb1a8,0xb3402e1f,0xb2250000,0xa9c53364
.long 0x3000,0xae1f0000,0x2e1fb000,0x0,0xae1f3000,0x80000000,0x3000,0xae1f0000
.long 0x3364b000,0x8000b1a8,0x8000b000,0xb36431a8,0x8000b000,0xb36431a8,0xb3643000,0x31a8
.long 0x2ace8000,0xae010000,0x2d17b1a8,0x24c70000,0xad1731a8,0xa4c70000,0x2ace8000,0xae010000
.long 0x3225b1a8,0xa9c5ae1f,0xb01b0000,0xb3403364,0xb01b0000,0xb3403364,0xb22531a8,0x29c52e1f
.long 0xada83000,0x2da80000,0xb2d43000,0xb2d43400,0xb2d43000,0xb2d43400,0x2da8b000,0xada88000
.long 0xada83000,0x2da80000,0x28b0b000,0x28b00000,0xa8b03000,0xa8b00000,0xada83000,0x2da80000
.long 0xa9c53000,0x3225ae1f,0xb3403000,0xb01b3364,0xb3403000,0xb01b3364,0x29c5b000,0xb2252e1f
.long 0xae013000,0x2ace0000,0x24c7b000,0x2d170000,0xa4c73000,0xad170000,0xae013000,0x2ace0000
.long 0x80003000,0x3364b1a8,0xb3643000,0x800031a8,0xb3643000,0x800031a8,0xb000,0xb36431a8
.long 0xae1f3000,0x0,0xb000,0x2e1f0000,0x80003000,0xae1f0000,0xae1f3000,0x0
.long 0x29c53000,0x3225b364,0xb3403000,0x301b2e1f,0xb3403000,0x301b2e1f,0xa9c5b000,0xb2253364
.long 0xae013000,0xaace0000,0xa4c7b000,0x2d170000,0x24c73000,0xad178000,0xae013000,0xaace0000
.long 0x2da8b000,0xada88000,0xa8b03000,0xa8b00000,0xa8b03000,0xa8b00000,0xada83000,0x2da80000
.long 0x2da8b000,0xada88000,0x32d4b000,0x32d4b400,0xb2d43000,0xb2d43400,0x2da8b000,0xada88000
.long 0x2d17b1a8,0x24c78000,0x2ace0000,0xae018000,0x2ace0000,0xae018000,0xad1731a8,0xa4c70000
.long 0xb01b8000,0xb3403364,0x3225b1a8,0xa9c5ae1f,0xb22531a8,0x29c52e1f,0xb01b8000,0xb3403364
.long 0x8000b000,0x2e1f0000,0x2e1fb000,0x80000000,0x2e1fb000,0x80000000,0x3000,0xae1f0000
.long 0xb3643000,0x800031a8,0x8000b000,0xb36431a8,0x3000,0x3364b1a8,0xb3643000,0x800031a8
.long 0xad178000,0x24c78000,0x2aceb1a8,0x2e018000,0x2aceb1a8,0x2e018000,0x2d170000,0xa4c70000
.long 0xb01b31a8,0x3340ae1f,0xb2258000,0xa9c53364,0x32250000,0x29c5b364,0xb01b31a8,0x3340ae1f
.long 0xada83000,0x2da80000,0xb2d43000,0xb2d43400,0xb2d43000,0xb2d43400,0x2da8b000,0xada88000
.long 0xada83000,0x2da80000,0x28b0b000,0x28b00000,0xa8b03000,0xa8b00000,0xada83000,0x2da80000
.long 0x3340b000,0x301bb364,0xa9c53000,0x3225ae1f,0xa9c53000,0x3225ae1f,0xb3403000,0xb01b3364
.long 0xa4c73000,0xad178000,0xae013000,0x2ace0000,0x2e01b000,0xaace8000,0xa4c73000,0xad178000
.long 0xb000,0xb36431a8,0x3364b000,0xb1a8,0x3364b000,0xb1a8,0x80003000,0x3364b1a8
.long 0x2e1fb000,0x80008000,0x3000,0xae1f0000,0xb000,0x2e1f0000,0x2e1fb000,0x80008000
.long 0xb3403000,0x301b2e1f,0xa9c5b000,0xb2253364,0xa9c5b000,0xb2253364,0x3340b000,0xb01bae1f
.long 0xa4c7b000,0x2d178000,0x2e01b000,0x2ace0000,0xae013000,0xaace8000,0xa4c7b000,0x2d178000
.long 0x2da8b000,0xada88000,0xa8b03000,0xa8b00000,0xa8b03000,0xa8b00000,0xada83000,0x2da80000
.long 0x2da8b000,0xada88000,0x32d4b000,0x32d4b400,0xb2d43000,0xb2d43400,0x2da8b000,0xada88000
.long 0xaace8000,0x2e018000,0x2d17b1a8,0x24c70000,0x2d17b1a8,0x24c70000,0x2ace0000,0xae010000
.long 0xb22531a8,0x29c52e1f,0xb01b8000,0xb3403364,0x301b0000,0x3340b364,0xb22531a8,0x29c52e1f
.long 0x80003000,0xae1f0000,0xae1f3000,0x8000,0xae1f3000,0x8000,0xb000,0x2e1f0000
.long 0x3364b000,0xb1a8,0x80003000,0x3364b1a8,0xb000,0xb36431a8,0x3364b000,0xb1a8
.long 0x2aceb1a8,0x2e010000,0x2d170000,0xa4c70000,0x2d170000,0xa4c70000,0xaace31a8,0xae010000
.long 0xb2258000,0xa9c53364,0x301bb1a8,0xb3402e1f,0xb01b31a8,0x3340ae1f,0xb2258000,0xa9c53364
.long 0xada83000,0x2da80000,0xb2d43000,0xb2d43400,0xb2d43000,0xb2d43400,0x2da8b000,0xada88000
.long 0xada83000,0x2da80000,0x28b0b000,0x28b00000,0xa8b03000,0xa8b00000,0xada83000,0x2da80000
.long 0x29c5b000,0xb2252e1f,0x3340b000,0x301bb364,0x3340b000,0x301bb364,0xa9c53000,0x3225ae1f
.long 0x2e01b000,0xaace0000,0xa4c73000,0xad170000,0x24c7b000,0x2d178000,0x2e01b000,0xaace0000
.long 0x80003000,0x3364b1a8,0xb3643000,0x800031a8,0xb3643000,0x800031a8,0xb000,0xb36431a8
.long 0xae1f3000,0x0,0xb000,0x2e1f0000,0x80003000,0xae1f0000,0xae1f3000,0x0
.long 0xa9c5b000,0xb2253364,0x3340b000,0xb01bae1f,0x3340b000,0xb01bae1f,0x29c53000,0x3225b364
.long 0x2e01b000,0x2ace0000,0x24c73000,0xad178000,0xa4c7b000,0x2d170000,0x2e01b000,0x2ace0000
.long 0x2da8b000,0xada88000,0xa8b03000,0xa8b00000,0xa8b03000,0xa8b00000,0xada83000,0x2da80000
.long 0x2da8b000,0xada88000,0x32d4b000,0x32d4b400,0xb2d43000,0xb2d43400,0x2da8b000,0xada88000
.long 0xad1731a8,0xa4c78000,0xaace8000,0x2e018000,0xaace8000,0x2e018000,0x2d17b1a8,0x24c70000
.long 0x301b0000,0x3340b364,0xb22531a8,0x29c52e1f,0x3225b1a8,0xa9c5ae1f,0x301b0000,0x3340b364
.long 0x8000b000,0x2e1f0000,0x2e1fb000,0x80000000,0x2e1fb000,0x80000000,0x3000,0xae1f0000
.long 0xb3643000,0x800031a8,0x8000b000,0xb36431a8,0x3000,0x3364b1a8,0xb3643000,0x800031a8
.long 0x2d170000,0xa4c70000,0xaace31a8,0xae010000,0xaace31a8,0xae010000,0xad178000,0x24c78000
.long 0x301bb1a8,0xb3402e1f,0x32250000,0x29c5b364,0xb2258000,0xa9c53364,0x301bb1a8,0xb3402e1f
.long 0xada83000,0x2da80000,0xb2d43000,0xb2d43400,0xb2d43000,0xb2d43400,0x2da8b000,0xada88000
.long 0xada83000,0x2da80000,0x28b0b000,0x28b00000,0xa8b03000,0xa8b00000,0xada83000,0x2da80000
.long 0xb3403000,0xb01b3364,0x29c5b000,0xb2252e1f,0x29c5b000,0xb2252e1f,0x3340b000,0x301bb364
.long 0x24c7b000,0x2d170000,0x2e01b000,0xaace8000,0xae013000,0x2ace0000,0x24c7b000,0x2d170000
.long 0xb000,0xb36431a8,0x3364b000,0xb1a8,0x3364b000,0xb1a8,0x80003000,0x3364b1a8
.long 0x2e1fb000,0x80008000,0x3000,0xae1f0000,0xb000,0x2e1f0000,0x2e1fb000,0x80008000
.long 0x3340b000,0xb01bae1f,0x29c53000,0x3225b364,0x29c53000,0x3225b364,0xb3403000,0x301b2e1f
.long 0x24c73000,0xad178000,0xae013000,0xaace0000,0x2e01b000,0x2ace8000,0x24c73000,0xad178000
.long 0x2da8b000,0xada88000,0xa8b03000,0xa8b00000,0xa8b03000,0xa8b00000,0xada83000,0x2da80000
.long 0x2da8b000,0xada88000,0x32d4b000,0x32d4b400,0xb2d43000,0xb2d43400,0x2da8b000,0xada88000
.long 0x2ace0000,0xae010000,0xad1731a8,0xa4c70000,0xad1731a8,0xa4c70000,0xaace8000,0x2e018000
.long 0x3225b1a8,0xa9c5ae1f,0x301b0000,0x3340b364,0xb01b8000,0xb3403364,0x3225b1a8,0xa9c5ae1f
.long 0x80003000,0xae1f0000,0xae1f3000,0x8000,0xae1f3000,0x8000,0xb000,0x2e1f0000
.long 0x3364b000,0xb1a8,0x80003000,0x3364b1a8,0xb000,0xb36431a8,0x3364b000,0xb1a8
.long 0xaace31a8,0xae018000,0xad178000,0x24c70000,0xad178000,0x24c70000,0x2aceb1a8,0x2e010000
.long 0x32250000,0x29c5b364,0xb01b31a8,0x3340ae1f,0x301bb1a8,0xb3402e1f,0x32250000,0x29c5b364
.long 0x32d43000,0xb2d48000,0xada83000,0xada8b400,0xada83000,0xada8b400,0xb2d4b000,0x32d40000
.long 0xa8b03000,0x28b08000,0xada8b000,0xada80000,0x2da83000,0x2da80000,0xa8b03000,0x28b08000
.long 0x33403000,0xb01b2e1f,0xa9c53000,0xb225b364,0xa9c53000,0xb225b364,0xb340b000,0x301bae1f
.long 0xa4c73000,0x2d170000,0xae01b000,0xaace0000,0x2e013000,0x2ace8000,0xa4c73000,0x2d170000
.long 0x33643000,0x31a8,0x80003000,0xb364b1a8,0x80003000,0xb364b1a8,0xb364b000,0x8000b1a8
.long 0x80003000,0x2e1f8000,0xae1fb000,0x0,0x2e1f3000,0x80000000,0x80003000,0x2e1f8000
.long 0x33403000,0x301b3364,0x29c53000,0xb225ae1f,0x29c53000,0xb225ae1f,0xb340b000,0xb01bb364
.long 0x24c73000,0x2d170000,0xae01b000,0x2ace8000,0x2e013000,0xaace0000,0x24c73000,0x2d170000
.long 0x28b0b000,0xa8b08000,0x2da83000,0x2da80000,0x2da83000,0x2da80000,0xa8b03000,0x28b00000
.long 0xb2d4b000,0x32d40000,0x2da8b000,0x2da83400,0xada83000,0xada8b400,0xb2d4b000,0x32d40000
.long 0xaaceb1a8,0xae018000,0x2d170000,0xa4c78000,0x2d170000,0xa4c78000,0x2ace31a8,0x2e010000
.long 0xb2258000,0xa9c5b364,0xb01bb1a8,0x33402e1f,0x301b31a8,0xb340ae1f,0xb2258000,0xa9c5b364
.long 0xae1fb000,0x80000000,0xb000,0xae1f8000,0xb000,0xae1f8000,0x2e1f3000,0x0
.long 0x80003000,0xb364b1a8,0xb364b000,0xb1a8,0x33643000,0x800031a8,0x80003000,0xb364b1a8
.long 0xaace8000,0x2e010000,0xad17b1a8,0xa4c70000,0xad17b1a8,0xa4c70000,0x2ace0000,0xae018000
.long 0x322531a8,0xa9c52e1f,0xb01b8000,0xb340b364,0x301b0000,0x33403364,0x322531a8,0xa9c52e1f
.long 0x32d43000,0xb2d48000,0xada83000,0xada8b400,0xada83000,0xada8b400,0xb2d4b000,0x32d40000
.long 0xa8b03000,0x28b08000,0xada8b000,0xada80000,0x2da83000,0x2da80000,0xa8b03000,0x28b08000
.long 0x29c5b000,0x32253364,0x33403000,0xb01b2e1f,0x33403000,0xb01b2e1f,0xa9c53000,0xb225b364
.long 0x2e013000,0x2ace0000,0xa4c73000,0x2d178000,0x24c7b000,0xad170000,0x2e013000,0x2ace0000
.long 0xb364b000,0xb1a8,0xb000,0x336431a8,0xb000,0x336431a8,0x33643000,0x800031a8
.long 0xb000,0xae1f0000,0x2e1f3000,0x0,0xae1fb000,0x80000000,0xb000,0xae1f0000
.long 0x29c53000,0xb225ae1f,0xb340b000,0xb01bb364,0xb340b000,0xb01bb364,0xa9c5b000,0x32252e1f
.long 0xae01b000,0x2ace8000,0xa4c7b000,0xad170000,0x24c73000,0x2d178000,0xae01b000,0x2ace8000
.long 0x28b0b000,0xa8b08000,0x2da83000,0x2da80000,0x2da83000,0x2da80000,0xa8b03000,0x28b00000
.long 0xb2d4b000,0x32d40000,0x2da8b000,0x2da83400,0xada83000,0xada8b400,0xb2d4b000,0x32d40000
.long 0xad178000,0x24c70000,0xaaceb1a8,0xae010000,0xaaceb1a8,0xae010000,0x2d170000,0xa4c78000
.long 0x301b31a8,0xb340ae1f,0xb2258000,0xa9c5b364,0x32250000,0x29c53364,0x301b31a8,0xb340ae1f
.long 0x2e1f3000,0x0,0x80003000,0x2e1f0000,0x80003000,0x2e1f0000,0xae1fb000,0x0
.long 0xb000,0x336431a8,0x33643000,0x800031a8,0xb364b000,0xb1a8,0xb000,0x336431a8
.long 0xad17b1a8,0xa4c78000,0x2ace0000,0xae010000,0x2ace0000,0xae010000,0x2d1731a8,0x24c70000
.long 0xb01b8000,0xb340b364,0xb225b1a8,0x29c5ae1f,0x322531a8,0xa9c52e1f,0xb01b8000,0xb340b364
.long 0x32d43000,0xb2d48000,0xada83000,0xada8b400,0xada83000,0xada8b400,0xb2d4b000,0x32d40000
.long 0xa8b03000,0x28b08000,0xada8b000,0xada80000,0x2da83000,0x2da80000,0xa8b03000,0x28b08000
.long 0xb340b000,0x301bae1f,0x29c5b000,0x32253364,0x29c5b000,0x32253364,0x33403000,0xb01b2e1f
.long 0x24c7b000,0xad170000,0x2e013000,0x2ace0000,0xae01b000,0xaace0000,0x24c7b000,0xad170000
.long 0x33643000,0x31a8,0x80003000,0xb364b1a8,0x80003000,0xb364b1a8,0xb364b000,0x8000b1a8
.long 0x80003000,0x2e1f8000,0xae1fb000,0x0,0x2e1f3000,0x80000000,0x80003000,0x2e1f8000
.long 0xb340b000,0xb01bb364,0xa9c5b000,0x32252e1f,0xa9c5b000,0x32252e1f,0x33403000,0x301b3364
.long 0xa4c7b000,0xad170000,0x2e013000,0xaace0000,0xae01b000,0x2ace8000,0xa4c7b000,0xad170000
.long 0x28b0b000,0xa8b08000,0x2da83000,0x2da80000,0x2da83000,0x2da80000,0xa8b03000,0x28b00000
.long 0xb2d4b000,0x32d40000,0x2da8b000,0x2da83400,0xada83000,0xada8b400,0xb2d4b000,0x32d40000
.long 0x2ace31a8,0x2e018000,0xad178000,0x24c78000,0xad178000,0x24c78000,0xaaceb1a8,0xae010000
.long 0x32250000,0x29c53364,0x301b31a8,0xb340ae1f,0xb01bb1a8,0x33402e1f,0x32250000,0x29c53364
.long 0xae1fb000,0x80000000,0xb000,0xae1f8000,0xb000,0xae1f8000,0x2e1f3000,0x0
.long 0x80003000,0xb364b1a8,0xb364b000,0xb1a8,0x33643000,0x800031a8,0x80003000,0xb364b1a8
.long 0x2ace0000,0xae018000,0x2d1731a8,0x24c78000,0x2d1731a8,0x24c78000,0xaace8000,0x2e010000
.long 0xb225b1a8,0x29c5ae1f,0x301b0000,0x33403364,0xb01b8000,0xb340b364,0xb225b1a8,0x29c5ae1f
.long 0x32d43000,0xb2d48000,0xada83000,0xada8b400,0xada83000,0xada8b400,0xb2d4b000,0x32d40000
.long 0xa8b03000,0x28b08000,0xada8b000,0xada80000,0x2da83000,0x2da80000,0xa8b03000,0x28b08000
.long 0xa9c53000,0xb225b364,0xb340b000,0x301bae1f,0xb340b000,0x301bae1f,0x29c5b000,0x32253364
.long 0xae01b000,0xaace8000,0x24c7b000,0xad170000,0xa4c73000,0x2d178000,0xae01b000,0xaace8000
.long 0xb364b000,0xb1a8,0xb000,0x336431a8,0xb000,0x336431a8,0x33643000,0x800031a8
.long 0xb000,0xae1f0000,0x2e1f3000,0x0,0xae1fb000,0x80000000,0xb000,0xae1f0000
.long 0xa9c5b000,0x32252e1f,0x33403000,0x301b3364,0x33403000,0x301b3364,0x29c53000,0xb225ae1f
.long 0x2e013000,0xaace8000,0x24c73000,0x2d170000,0xa4c7b000,0xad178000,0x2e013000,0xaace8000
.long 0x28b0b000,0xa8b08000,0x2da83000,0x2da80000,0x2da83000,0x2da80000,0xa8b03000,0x28b00000
.long 0xb2d4b000,0x32d40000,0x2da8b000,0x2da83400,0xada83000,0xada8b400,0xb2d4b000,0x32d40000
.long 0x2d170000,0xa4c78000,0x2ace31a8,0x2e010000,0x2ace31a8,0x2e010000,0xad178000,0x24c70000
.long 0xb01bb1a8,0x33402e1f,0x32250000,0x29c53364,0xb2258000,0xa9c5b364,0xb01bb1a8,0x33402e1f
.long 0x2e1f3000,0x0,0x80003000,0x2e1f0000,0x80003000,0x2e1f0000,0xae1fb000,0x0
.long 0xb000,0x336431a8,0x33643000,0x800031a8,0xb364b000,0xb1a8,0xb000,0x336431a8
.long 0x2d1731a8,0x24c70000,0xaace8000,0x2e010000,0xaace8000,0x2e010000,0xad17b1a8,0xa4c70000
.long 0x301b0000,0x33403364,0x322531a8,0xa9c52e1f,0xb225b1a8,0x29c5ae1f,0x301b0000,0x33403364
.long 0x3c003c00,0x3c003c00,0x0,0x0,0x3c003c00,0x3bff3c00,0x21070000,0x278a2507
.long 0x3c003c00,0x3bfc3bfe,0x25070000,0x2b892906,0x3bff3c00,0x3bf83bfc,0x278a0000,0x2da62b89
.long 0x3bfe3c00,0x3bf23bfa,0x29060000,0x2f862d05,0x3bfe3c00,0x3bea3bf6,0x2a480000,0x30b22e46
.long 0x3bfc3c00,0x3be03bf2,0x2b890000,0x31a02f86,0x3bfb3c00,0x3bd53bed,0x2c650000,0x328d3062
.long 0x3bfa3c00,0x3bc73be7,0x2d050000,0x33783102,0x3bf83c00,0x3bb83be0,0x2da60000,0x343131a0
.long 0x3bf63c00,0x3ba83bd9,0x2e460000,0x34a5323e,0x3bf43c00,0x3b953bd0,0x2ee60000,0x351832dc
.long 0x3bf23c00,0x3b813bc7,0x2f860000,0x358a3378,0x3bef3c00,0x3b6c3bbe,0x30130000,0x35fa340a
.long 0x3bed3c00,0x3b543bb3,0x30620000,0x36693458,0x3bea3c00,0x3b3b3ba8,0x30b20000,0x36d734a5
.long 0x3c003c00,0x3c003c00,0x0,0x0,0x3bfe3bfe,0x3bfb3bfc,0x2a482906,0x2c652b89
.long 0x3bf63bfa,0x3bed3bf2,0x2e462d05,0x30622f86,0x3bea3bf2,0x3bd53be0,0x30b22f86,0x328d31a0
.long 0x3bd93be7,0x3bb33bc7,0x323e3102,0x34583378,0x3bc33bd9,0x3b883ba8,0x33c6323e,0x356434a5
.long 0x3ba83bc7,0x3b543b81,0x34a53378,0x3669358a,0x3b883bb3,0x3b183b54,0x35643458,0x37673669
.long 0x3b643b9c,0x3ad23b21,0x361f34f2,0x382e3744,0x3b3b3b81,0x3a853ae7,0x36d7358a,0x38a3380c
.long 0x3b0e3b64,0x3a2f3aa7,0x378b361f,0x39133872,0x3add3b44,0x39d23a61,0x381d36b3,0x397d38d4
.long 0x3aa73b21,0x396e3a15,0x38723744,0x39e03932,0x3a6d3afb,0x390439c4,0x38c437d1,0x3a3c398b
.long 0x3a2f3ad2,0x3893396e,0x3913382e,0x3a9039e0,0x39ed3aa7,0x381d3913,0x395f3872,0x3add3a2f
.long 0x3c003c00,0x3c003c00,0x0,0x0,0x3bf83bfa,0x3bf43bf6,0x2da62d05,0x2ee62e46
.long 0x3be03be7,0x3bd03bd9,0x31a03102,0x32dc323e,0x3bb83bc7,0x3b953ba8,0x34313378,0x351834a5
.long 0x3b813b9c,0x3b443b64,0x358a34f2,0x36b3361f,0x3b3b3b64,0x3add3b0e,0x36d7361f,0x381d378b
.long 0x3ae73b21,0x3a613aa7,0x380c3744,0x38d43872,0x3a853ad2,0x39d23a2f,0x38a3382e,0x397d3913
.long 0x3a153a79,0x393239a8,0x393238b4,0x3a1539a8,0x399a3a15,0x38823913,0x39b63932,0x3a9c3a2f
.long 0x391339a8,0x378b3872,0x3a2f39a8,0x3b0e3aa7,0x38823932,0x35fa378b,0x3a9c3a15,0x3b6c3b0e
.long 0x37d138b4,0x3458361f,0x3afb3a79,0x3bb33b64,0x368e382e,0x315134a5,0x3b4c3ad2,0x3be43ba8
.long 0x353e3744,0x2b89323e,0x3b8f3b21,0x3bfc3bd9,0x33c6361f,0xaa482e46,0x3bc33b64,0x3bfe3bf6
.long 0x3c003c00,0x3c003c00,0x0,0x0,0x3bef3bf2,0x3bea3bed,0x30132f86,0x30b23062
.long 0x3bbe3bc7,0x3ba83bb3,0x340a3378,0x34a53458,0x3b6c3b81,0x3b3b3b54,0x35fa358a,0x36d73669
.long 0x3afb3b21,0x3aa73ad2,0x37d13744,0x3872382e,0x3a6d3aa7,0x39ed3a2f,0x38c43872,0x395f3913
.long 0x39c43a15,0x3913396e,0x398b3932,0x3a2f39e0,0x3904396e,0x381d3893,0x3a3c39e0,0x3add3a90
.long 0x382e38b4,0x361f3744,0x3ad23a79,0x3b643b21,0x368e37d1,0x33c6353e,0x3b4c3afb,0x3bc33b8f
.long 0x34a5361f,0x2e46323e,0x3ba83b64,0x3bf63bd9,0x31513458,0xaa482b89,0x3be43bb3,0x3bfe3bfc
.long 0x29063102,0xb23ead05,0x3bfe3be7,0x3bd93bfa,0xada62906,0xb564b2dc,0x3bf83bfe,0x3b883bd0
.long 0xb2dcad05,0xb78bb58a,0x3bd03bfa,0x3b0e3b81,0xb564b23e,0xb8c4b78b,0x3b883bd9,0x3a6d3b0e
.long 0x3c003c00,0x3c003c00,0x0,0x0,0x3be43be7,0x3bdc3be0,0x31513102,0x31ef31a0
.long 0x3b8f3b9c,0x3b733b81,0x353e34f2,0x35d5358a,0x3b053b21,0x3ac83ae7,0x37ae3744,0x383f380c
.long 0x3a483a79,0x39e03a15,0x38f438b4,0x396e3932,0x395f39a8,0x38c43913,0x39ed39a8,0x3a6d3a2f
.long 0x385038b4,0x36fc37d1,0x3abd3a79,0x3b333afb,0x36453744,0x3431353e,0x3b5c3b21,0x3bb83b8f
.long 0x337834f2,0x2d053102,0x3bc73b9c,0x3bfa3be7,0x2c653102,0xaee6a507,0x3bfb3be7,0x3bf43c00
.long 0xae460000,0xb4a5b23e,0x3bf63c00,0x3ba83bd9,0xb431b102,0xb767b5d5,0x3bb83be7,0x3b183b73
.long 0xb6b3b4f2,0xb8f4b82e,0x3b443b9c,0x3a483ad2,0xb882b744,0xba08b950,0x3a9c3b21,0x394139fb
.long 0xb98bb8b4,0xbae7ba48,0x39c43a79,0x380c38f4,0xba6db9a8,0xbb88bb0e,0x38c439a8,0x3564378b
.long 0x3c003c00,0x3c003c00,0x0,0x0,0x3bd53bd9,0x3bcc3bd0,0x328d323e,0x332a32dc
.long 0x3b543b64,0x3b333b44,0x3669361f,0x36fc36b3,0x3a853aa7,0x3a3c3a61,0x38a33872,0x390438d4
.long 0x396e39a8,0x38f43932,0x39e039a8,0x3a483a15,0x381d3872,0x36d7378b,0x3add3aa7,0x3b3b3b0e
.long 0x353e361f,0x32dc3458,0x3b8f3b64,0x3bd03bb3,0x3013323e,0xa1072b89,0x3bef3bd9,0x3c003bfc
.long 0xad050000,0xb378b102,0x3bfa3c00,0x3bc73be7,0xb47eb23e,0xb720b5d5,0x3bae3bd9,0x3b2a3b73
.long 0xb78bb61f,0xb913b872,0x3b0e3b64,0x3a2f3aa7,0xb923b872,0xba55b9c4,0x3a223aa7,0x38e4398b
.long 0xba48b9a8,0xbb44bad2,0x38f439a8,0x36b3382e,0xbb2abaa7,0xbbd5bb8f,0x37203872,0x328d353e
.long 0xbbbebb64,0xbc00bbf2,0x340a361f,0xa5072f86,0xbbfebbd9,0xbbc3bbf6,0x2a48323e,0xb3c6ae46
.long 0x3c003c00,0x3c003c00,0x0,0x0,0x3bc33bc7,0x3bb83bbe,0x33c63378,0x3431340a
.long 0x3b0e3b21,0x3ae73afb,0x378b3744,0x380c37d1,0x39ed3a15,0x399a39c4,0x395f3932,0x39b6398b
.long 0x387238b4,0x37d1382e,0x3aa73a79,0x3afb3ad2,0x3564361f,0x33c634a5,0x3b883b64,0x3bc33ba8
.long 0x2e463102,0xa5072906,0x3bf63be7,0x3c003bfe,0xb0b2ad05,0xb47eb2dc,0x3bea3bfa,0x3bae3bd0
.long 0xb61fb4f2,0xb82eb744,0x3b643b9c,0x3ad23b21,0xb8c4b82e,0xb9d2b950,0x3a6d3ad2,0x397d39fb
.long 0xba2fb9a8,0xbb0ebaa7,0x391339a8,0x378b3872,0xbb3bbad2,0xbbccbb8f,0x36d7382e,0x332a353e
.long 0xbbd9bb9c,0xbbfebbfa,0x323e34f2,0xa9062d05,0xbbfebbfa,0xbba2bbe0,0xaa482d05,0xb4cbb1a0
.long 0xbba8bbe7,0xbabdbb44,0xb4a5b102,0xb850b6b3,0xbaddbb64,0xb95fba2f,0xb81db61f,0xb9edb913
.long 0x3c003c00,0x3c003c00,0x0,0x0,0x3bae3bb3,0x3ba23ba8,0x347e3458,0x34cb34a5
.long 0x3abd3ad2,0x3a903aa7,0x3850382e,0x38933872,0x3941396e,0x38e43913,0x3a0839e0,0x3a553a2f
.long 0x36b33744,0x358a361f,0x3b443b21,0x3b813b64,0x30b2323e,0x2a482e46,0x3bea3bd9,0x3bfe3bf6
.long 0xb062ad05,0xb40ab23e,0x3bed3bfa,0x3bbe3bd9,0xb68eb58a,0xb83fb78b,0x3b4c3b81,0x3ac83b0e
.long 0xb932b8b4,0xba15b9a8,0x3a153a79,0x393239a8,0xbab2ba48,0xbb5cbb0e,0x386138f4,0x3645378b
.long 0xbba8bb64,0xbbf6bbd9,0x34a5361f,0x2e46323e,0xbc00bbf2,0xbbd5bbf6,0x21072f86,0xb28dae46
.long 0xbbb3bbe7,0xbafbbb64,0xb458b102,0xb7d1b61f,0xbac8bb44,0xb97dba2f,0xb83fb6b3,0xb9d2b913
.long 0xb950ba15,0xb6fcb872,0xb9fbb932,0xbb33baa7,0xb6d7b872,0xb0b2b4a5,0xbb3bbaa7,0xbbeabba8
.long 0x500,0x278,0x78,0xf8,0x0,0x4,0x80,0x100
.long 0x8,0xc,0x88,0x108,0x10,0x14,0x90,0x110
.long 0x18,0x1c,0x98,0x118,0x20,0x24,0xa0,0x120
.long 0x28,0x2c,0xa8,0x128,0x30,0x34,0xb0,0x130
.long 0x38,0x3c,0xb8,0x138,0x40,0x44,0xc0,0x140
.long 0x48,0x4c,0xc8,0x148,0x50,0x54,0xd0,0x150
.long 0x58,0x5c,0xd8,0x158,0x60,0x64,0xe0,0x160
.long 0x68,0x6c,0xe8,0x168,0x70,0x74,0xf0,0x170
.long 0x27c,0x4f8,0x2f8,0x378,0x280,0x284,0x300,0x380
.long 0x288,0x28c,0x308,0x388,0x290,0x294,0x310,0x390
.long 0x298,0x29c,0x318,0x398,0x2a0,0x2a4,0x320,0x3a0
.long 0x2a8,0x2ac,0x328,0x3a8,0x2b0,0x2b4,0x330,0x3b0
.long 0x2b8,0x2bc,0x338,0x3b8,0x2c0,0x2c4,0x340,0x3c0
.long 0x2c8,0x2cc,0x348,0x3c8,0x2d0,0x2d4,0x350,0x3d0
.long 0x2d8,0x2dc,0x358,0x3d8,0x2e0,0x2e4,0x360,0x3e0
.long 0x2e8,0x2ec,0x368,0x3e8,0x2f0,0x2f4,0x370,0x3f0
.long 0x4f8,0x4fc,0x478,0x3f8,0x4f0,0x4f4,0x470,0x3f0
.long 0x4e8,0x4ec,0x468,0x3e8,0x4e0,0x4e4,0x460,0x3e0
.long 0x4d8,0x4dc,0x458,0x3d8,0x4d0,0x4d4,0x450,0x3d0
.long 0x4c8,0x4cc,0x448,0x3c8,0x4c0,0x4c4,0x440,0x3c0
.long 0x4b8,0x4bc,0x438,0x3b8,0x4b0,0x4b4,0x430,0x3b0
.long 0x4a8,0x4ac,0x428,0x3a8,0x4a0,0x4a4,0x420,0x3a0
.long 0x498,0x49c,0x418,0x398,0x490,0x494,0x410,0x390
.long 0x488,0x48c,0x408,0x388,0x480,0x484,0x400,0x380
.long 0x278,0x27c,0x1f8,0x178,0x270,0x274,0x1f0,0x170
.long 0x268,0x26c,0x1e8,0x168,0x260,0x264,0x1e0,0x160
.long 0x258,0x25c,0x1d8,0x158,0x250,0x254,0x1d0,0x150
.long 0x248,0x24c,0x1c8,0x148,0x240,0x244,0x1c0,0x140
.long 0x238,0x23c,0x1b8,0x138,0x230,0x234,0x1b0,0x130
.long 0x228,0x22c,0x1a8,0x128,0x220,0x224,0x1a0,0x120
.long 0x218,0x21c,0x198,0x118,0x210,0x214,0x190,0x110
.long 0x208,0x20c,0x188,0x108,0x200,0x204,0x180,0x100
.long 0x178,0x1f8,0x0,0x0,0x180,0x200,0x0,0x0
.long 0x188,0x208,0x0,0x0,0x190,0x210,0x0,0x0
.long 0x198,0x218,0x0,0x0,0x1a0,0x220,0x0,0x0
.long 0x1a8,0x228,0x0,0x0,0x1b0,0x230,0x0,0x0
.long 0x1b8,0x238,0x0,0x0,0x1c0,0x240,0x0,0x0
.long 0x1c8,0x248,0x0,0x0,0x1d0,0x250,0x0,0x0
.long 0x1d8,0x258,0x0,0x0,0x1e0,0x260,0x0,0x0
.long 0x1e8,0x268,0x0,0x0,0x1f0,0x270,0x0,0x0
.long 0x3f8,0x478,0x0,0x0,0x400,0x480,0x0,0x0
.long 0x408,0x488,0x0,0x0,0x410,0x490,0x0,0x0
.long 0x418,0x498,0x0,0x0,0x420,0x4a0,0x0,0x0
.long 0x428,0x4a8,0x0,0x0,0x430,0x4b0,0x0,0x0
.long 0x438,0x4b8,0x0,0x0,0x440,0x4c0,0x0,0x0
.long 0x448,0x4c8,0x0,0x0,0x450,0x4d0,0x0,0x0
.long 0x458,0x4d8,0x0,0x0,0x460,0x4e0,0x0,0x0
.long 0x468,0x4e8,0x0,0x0,0x470,0x4f0,0x0,0x0
.long 0x378,0x2f8,0x0,0x0,0x370,0x2f0,0x0,0x0
.long 0x368,0x2e8,0x0,0x0,0x360,0x2e0,0x0,0x0
.long 0x358,0x2d8,0x0,0x0,0x350,0x2d0,0x0,0x0
.long 0x348,0x2c8,0x0,0x0,0x340,0x2c0,0x0,0x0
.long 0x338,0x2b8,0x0,0x0,0x330,0x2b0,0x0,0x0
.long 0x328,0x2a8,0x0,0x0,0x320,0x2a0,0x0,0x0
.long 0x318,0x298,0x0,0x0,0x310,0x290,0x0,0x0
.long 0x308,0x288,0x0,0x0,0x300,0x280,0x0,0x0
.long 0xf8,0x78,0x0,0x0,0xf0,0x70,0x0,0x0
.long 0xe8,0x68,0x0,0x0,0xe0,0x60,0x0,0x0
.long 0xd8,0x58,0x0,0x0,0xd0,0x50,0x0,0x0
.long 0xc8,0x48,0x0,0x0,0xc0,0x40,0x0,0x0
.long 0xb8,0x38,0x0,0x0,0xb0,0x30,0x0,0x0
.long 0xa8,0x28,0x0,0x0,0xa0,0x20,0x0,0x0
.long 0x98,0x18,0x0,0x0,0x90,0x10,0x0,0x0
.long 0x88,0x8,0x0,0x0,0x80,0x0,0x0,0x0
.long 0x32e0,0x32e0,0x327c,0x313c,0x3000,0x3140,0x3278,0x3138
.long 0x3004,0x3144,0x3274,0x3134,0x3008,0x3148,0x3270,0x3130
.long 0x300c,0x314c,0x326c,0x312c,0x3010,0x3150,0x3268,0x3128
.long 0x3014,0x3154,0x3264,0x3124,0x3018,0x3158,0x3260,0x3120
.long 0x301c,0x315c,0x325c,0x311c,0x3020,0x3160,0x3258,0x3118
.long 0x3024,0x3164,0x3280,0x3280,0x3290,0x3290,0x3290,0x3290
.long 0x32a0,0x32a0,0x32a0,0x32a0,0x32b0,0x32b0,0x32b0,0x32b0
.long 0x32c0,0x32c0,0x32c0,0x32c0,0x32d0,0x32d0,0x32d0,0x32d0
.long 0x304c,0x318c,0x32e4,0x32e4,0x3050,0x3190,0x3228,0x30e8
.long 0x3054,0x3194,0x3224,0x30e4,0x3058,0x3198,0x3220,0x30e0
.long 0x305c,0x319c,0x321c,0x30dc,0x3060,0x31a0,0x3218,0x30d8
.long 0x3064,0x31a4,0x3214,0x30d4,0x3068,0x31a8,0x3210,0x30d0
.long 0x306c,0x31ac,0x320c,0x30cc,0x3070,0x31b0,0x3208,0x30c8
.long 0x3074,0x31b4,0x3284,0x3284,0x3294,0x3294,0x3294,0x3294
.long 0x32a4,0x32a4,0x32a4,0x32a4,0x32b4,0x32b4,0x32b4,0x32b4
.long 0x32c4,0x32c4,0x32c4,0x32c4,0x32d4,0x32d4,0x32d4,0x32d4
.long 0x309c,0x31dc,0x32e8,0x32e8,0x30a0,0x31e0,0x31d8,0x3098
.long 0x30a4,0x31e4,0x31d4,0x3094,0x30a8,0x31e8,0x31d0,0x3090
.long 0x30ac,0x31ec,0x31cc,0x308c,0x30b0,0x31f0,0x31c8,0x3088
.long 0x30b4,0x31f4,0x31c4,0x3084,0x30b8,0x31f8,0x31c0,0x3080
.long 0x30bc,0x31fc,0x31bc,0x307c,0x30c0,0x3200,0x31b8,0x3078
.long 0x30c4,0x3204,0x3288,0x3288,0x3298,0x3298,0x3298,0x3298
.long 0x32a8,0x32a8,0x32a8,0x32a8,0x32b8,0x32b8,0x32b8,0x32b8
.long 0x32c8,0x32c8,0x32c8,0x32c8,0x32d8,0x32d8,0x32d8,0x32d8
.long 0x30ec,0x322c,0x32ec,0x32ec,0x30f0,0x3230,0x3188,0x3048
.long 0x30f4,0x3234,0x3184,0x3044,0x30f8,0x3238,0x3180,0x3040
.long 0x30fc,0x323c,0x317c,0x303c,0x3100,0x3240,0x3178,0x3038
.long 0x3104,0x3244,0x3174,0x3034,0x3108,0x3248,0x3170,0x3030
.long 0x310c,0x324c,0x316c,0x302c,0x3110,0x3250,0x3168,0x3028
.long 0x3114,0x3254,0x328c,0x328c,0x329c,0x329c,0x329c,0x329c
.long 0x32ac,0x32ac,0x32ac,0x32ac,0x32bc,0x32bc,0x32bc,0x32bc
.long 0x32cc,0x32cc,0x32cc,0x32cc,0x32dc,0x32dc,0x32dc,0x32dc
.long 0x3400,0x3400,0x3400,0x3400,0x3400,0x31a831a8,0x34000000,0x31a8b1a8
.long 0x3400,0x34000000,0xb400,0xb4008000,0x3400,0x31a8b1a8,0xb4008000,0x31a831a8
.long 0x3400,0xb400,0x3400,0xb400,0x3400,0xb1a8b1a8,0x34000000,0xb1a831a8
.long 0x3400,0xb4008000,0xb400,0x34000000,0x3400,0xb1a831a8,0xb4008000,0xb1a8b1a8
.long 0x3400,0x3400,0x3400,0x3400,0x3400,0x31a831a8,0x34000000,0x31a8b1a8
.long 0x3400,0x34000000,0xb400,0xb4008000,0x3400,0x31a8b1a8,0xb4008000,0x31a831a8
.long 0x3400,0xb400,0x3400,0xb400,0x3400,0xb1a8b1a8,0x34000000,0xb1a831a8
.long 0x3400,0xb4008000,0xb400,0x34000000,0x3400,0xb1a831a8,0xb4008000,0xb1a8b1a8
.long 0x3400,0x3400,0x3400,0x3400,0xb400,0xb1a8b1a8,0xb4008000,0xb1a831a8
.long 0x3400,0x34000000,0xb400,0xb4008000,0xb400,0xb1a831a8,0x34000000,0xb1a8b1a8
.long 0x3400,0xb400,0x3400,0xb400,0xb400,0x31a831a8,0xb4008000,0x31a8b1a8
.long 0x3400,0xb4008000,0xb400,0x34000000,0xb400,0x31a8b1a8,0x34000000,0x31a831a8
.long 0x3400,0x3400,0x3400,0x3400,0xb400,0xb1a8b1a8,0xb4008000,0xb1a831a8
.long 0x3400,0x34000000,0xb400,0xb4008000,0xb400,0xb1a831a8,0x34000000,0xb1a8b1a8
.long 0x3400,0xb400,0x3400,0xb400,0xb400,0x31a831a8,0xb4008000,0x31a8b1a8
.long 0x3400,0xb4008000,0xb400,0x34000000,0xb400,0x31a8b1a8,0x34000000,0x31a831a8
.long 0x3400,0x3400,0x3400,0x3400,0xae1f3364,0xb3642e1f,0xb364ae1f,0xae1fb364
.long 0xb1a831a8,0xb1a8b1a8,0x31a8b1a8,0x31a831a8,0xb3642e1f,0x2e1fb364,0x2e1f3364,0xb364ae1f
.long 0xb4008000,0x34000000,0xb4008000,0x34000000,0xb364ae1f,0x2e1f3364,0x2e1fb364,0xb3642e1f
.long 0xb1a8b1a8,0xb1a831a8,0x31a831a8,0x31a8b1a8,0xae1fb364,0xb364ae1f,0xb3642e1f,0xae1f3364
.long 0xb400,0xb400,0xb400,0xb400,0x2e1fb364,0x3364ae1f,0x33642e1f,0x2e1f3364
.long 0x31a8b1a8,0x31a831a8,0xb1a831a8,0xb1a8b1a8,0x3364ae1f,0xae1f3364,0xae1fb364,0x33642e1f
.long 0x34000000,0xb4008000,0x34000000,0xb4008000,0x33642e1f,0xae1fb364,0xae1f3364,0x3364ae1f
.long 0x31a831a8,0x31a8b1a8,0xb1a8b1a8,0xb1a831a8,0x2e1f3364,0x33642e1f,0x3364ae1f,0x2e1fb364
.long 0x3400,0x3400,0x3400,0x3400,0x2e1fb364,0x3364ae1f,0x33642e1f,0x2e1f3364
.long 0xb1a831a8,0xb1a8b1a8,0x31a8b1a8,0x31a831a8,0x3364ae1f,0xae1f3364,0xae1fb364,0x33642e1f
.long 0xb4008000,0x34000000,0xb4008000,0x34000000,0x33642e1f,0xae1fb364,0xae1f3364,0x3364ae1f
.long 0xb1a8b1a8,0xb1a831a8,0x31a831a8,0x31a8b1a8,0x2e1f3364,0x33642e1f,0x3364ae1f,0x2e1fb364
.long 0xb400,0xb400,0xb400,0xb400,0xae1f3364,0xb3642e1f,0xb364ae1f,0xae1fb364
.long 0x31a8b1a8,0x31a831a8,0xb1a831a8,0xb1a8b1a8,0xb3642e1f,0x2e1fb364,0x2e1f3364,0xb364ae1f
.long 0x34000000,0xb4008000,0x34000000,0xb4008000,0xb364ae1f,0x2e1f3364,0x2e1fb364,0xb3642e1f
.long 0x31a831a8,0x31a8b1a8,0xb1a8b1a8,0xb1a831a8,0xae1fb364,0xb364ae1f,0xb3642e1f,0xae1f3364
.long 0x34008000,0x34008000,0x34008000,0x34008000,0x34008000,0x31a8b1a8,0xb400,0xb1a8b1a8
.long 0x34008000,0xb400,0xb4008000,0x80003400,0x34008000,0xb1a8b1a8,0x80003400,0x31a8b1a8
.long 0x34008000,0xb4008000,0x34008000,0xb4008000,0x34008000,0xb1a831a8,0xb400,0x31a831a8
.long 0x34008000,0x80003400,0xb4008000,0xb400,0x34008000,0x31a831a8,0x80003400,0xb1a831a8
.long 0x34008000,0x34008000,0x34008000,0x34008000,0x34008000,0x31a8b1a8,0xb400,0xb1a8b1a8
.long 0x34008000,0xb400,0xb4008000,0x80003400,0x34008000,0xb1a8b1a8,0x80003400,0x31a8b1a8
.long 0x34008000,0xb4008000,0x34008000,0xb4008000,0x34008000,0xb1a831a8,0xb400,0x31a831a8
.long 0x34008000,0x80003400,0xb4008000,0xb400,0x34008000,0x31a831a8,0x80003400,0xb1a831a8
.long 0x34008000,0x34008000,0x34008000,0x34008000,0xb4008000,0xb1a831a8,0x80003400,0x31a831a8
.long 0x34008000,0xb400,0xb4008000,0x80003400,0xb4008000,0x31a831a8,0xb400,0xb1a831a8
.long 0x34008000,0xb4008000,0x34008000,0xb4008000,0xb4008000,0x31a8b1a8,0x80003400,0xb1a8b1a8
.long 0x34008000,0x80003400,0xb4008000,0xb400,0xb4008000,0xb1a8b1a8,0xb400,0x31a8b1a8
.long 0x34008000,0x34008000,0x34008000,0x34008000,0xb4008000,0xb1a831a8,0x80003400,0x31a831a8
.long 0x34008000,0xb400,0xb4008000,0x80003400,0xb4008000,0x31a831a8,0xb400,0xb1a831a8
.long 0x34008000,0xb4008000,0x34008000,0xb4008000,0xb4008000,0x31a8b1a8,0x80003400,0xb1a8b1a8
.long 0x34008000,0x80003400,0xb4008000,0xb400,0xb4008000,0xb1a8b1a8,0xb400,0x31a8b1a8
.long 0x34008000,0x34008000,0x34008000,0x34008000,0x33642e1f,0x2e1f3364,0xae1f3364,0xb3642e1f
.long 0x31a831a8,0xb1a831a8,0xb1a8b1a8,0x31a8b1a8,0x2e1f3364,0xb364ae1f,0x3364ae1f,0xae1f3364
.long 0x80003400,0xb400,0x80003400,0xb400,0xae1f3364,0x3364ae1f,0xb364ae1f,0x2e1f3364
.long 0xb1a831a8,0x31a831a8,0x31a8b1a8,0xb1a8b1a8,0xb3642e1f,0xae1f3364,0x2e1f3364,0x33642e1f
.long 0xb4008000,0xb4008000,0xb4008000,0xb4008000,0xb364ae1f,0xae1fb364,0x2e1fb364,0x3364ae1f
.long 0xb1a8b1a8,0x31a8b1a8,0x31a831a8,0xb1a831a8,0xae1fb364,0x33642e1f,0xb3642e1f,0x2e1fb364
.long 0xb400,0x80003400,0xb400,0x80003400,0x2e1fb364,0xb3642e1f,0x33642e1f,0xae1fb364
.long 0x31a8b1a8,0xb1a8b1a8,0xb1a831a8,0x31a831a8,0x3364ae1f,0x2e1fb364,0xae1fb364,0xb364ae1f
.long 0x34008000,0x34008000,0x34008000,0x34008000,0xb364ae1f,0xae1fb364,0x2e1fb364,0x3364ae1f
.long 0x31a831a8,0xb1a831a8,0xb1a8b1a8,0x31a8b1a8,0xae1fb364,0x33642e1f,0xb3642e1f,0x2e1fb364
.long 0x80003400,0xb400,0x80003400,0xb400,0x2e1fb364,0xb3642e1f,0x33642e1f,0xae1fb364
.long 0xb1a831a8,0x31a831a8,0x31a8b1a8,0xb1a8b1a8,0x3364ae1f,0x2e1fb364,0xae1fb364,0xb364ae1f
.long 0xb4008000,0xb4008000,0xb4008000,0xb4008000,0x33642e1f,0x2e1f3364,0xae1f3364,0xb3642e1f
.long 0xb1a8b1a8,0x31a8b1a8,0x31a831a8,0xb1a831a8,0x2e1f3364,0xb364ae1f,0x3364ae1f,0xae1f3364
.long 0xb400,0x80003400,0xb400,0x80003400,0xae1f3364,0x3364ae1f,0xb364ae1f,0x2e1f3364
.long 0x31a8b1a8,0xb1a8b1a8,0xb1a831a8,0x31a831a8,0xb3642e1f,0xae1f3364,0x2e1f3364,0x33642e1f
.long 0x3c003c00,0x3c003c00,0x0,0x0,0x3bfe3c00,0x3bea3bf6,0x2a480000,0x30b22e46
.long 0x3bf63c00,0x3ba83bd9,0x2e460000,0x34a5323e,0x3bea3c00,0x3b3b3ba8,0x30b20000,0x36d734a5
.long 0x3bd93c00,0x3aa73b64,0x323e0000,0x3872361f,0x3bc33c00,0x39ed3b0e,0x33c60000,0x395f378b
.long 0x3ba83c00,0x39133aa7,0x34a50000,0x3a2f3872,0x3b883c00,0x381d3a2f,0x35640000,0x3add3913
.long 0x3b643c00,0x361f39a8,0x361f0000,0x3b6439a8,0x3b3b3c00,0x33c63913,0x36d70000,0x3bc33a2f
.long 0x3b0e3c00,0x2e463872,0x378b0000,0x3bf63aa7,0x3add3c00,0xaa48378b,0x381d0000,0x3bfe3b0e
.long 0x3aa73c00,0xb23e361f,0x38720000,0x3bd93b64,0x3a6d3c00,0xb56434a5,0x38c40000,0x3b883ba8
.long 0x3a2f3c00,0xb78b323e,0x39130000,0x3b0e3bd9,0x39ed3c00,0xb8c42e46,0x395f0000,0x3a6d3bf6
.long 0x3c003c00,0x3c003c00,0x0,0x0,0x3bc33bd9,0x3b883ba8,0x33c6323e,0x356434a5
.long 0x3b0e3b64,0x3a2f3aa7,0x378b361f,0x39133872,0x39ed3aa7,0x381d3913,0x395f3872,0x3add3a2f
.long 0x387239a8,0x323e361f,0x3aa739a8,0x3bd93b64,0x35643872,0xb0b22e46,0x3b883aa7,0x3bea3bf6
.long 0x2e46361f,0xb78bb23e,0x3bf63b64,0x3b0e3bd9,0xb0b2323e,0xb9edb78b,0x3bea3bd9,0x395f3b0e
.long 0xb61f0000,0xbb64b9a8,0x3b643c00,0x361f39a8,0xb8c4b23e,0xbbfebb0e,0x3a6d3bd9,0x2a48378b
.long 0xba2fb61f,0xbba8bbd9,0x39133b64,0xb4a5323e,0xbb3bb872,0xba6dbbf6,0x36d73aa7,0xb8c4ae46
.long 0xbbd9b9a8,0xb872bb64,0x323e39a8,0xbaa7b61f,0xbbfebaa7,0xb3c6ba2f,0xaa483872,0xbbc3b913
.long 0xbba8bb64,0x2e46b872,0xb4a5361f,0xbbf6baa7,0xbaddbbd9,0x36d7b4a5,0xb81d323e,0xbb3bbba8
.long 0x3c003c00,0x3c003c00,0x0,0x0,0x3bfa3bff,0x3be23bf1,0x2cb52648,0x31792fd6
.long 0x3bea3bfe,0x3b883bc3,0x30b22a48,0x356433c6,0x3bce3bfa,0x3af63b77,0x33032cb5,0x37e335c2
.long 0x3ba83bf6,0x3a2f3b0e,0x34a52e46,0x3913378b,0x3b773bf1,0x393a3a8a,0x35c22fd6,0x3a0f389b
.long 0x3b3b3bea,0x381d39ed,0x36d730b2,0x3add395f,0x3af63be2,0x35c2393a,0x37e33179,0x3b773a0f
.long 0x3aa73bd9,0x323e3872,0x3872323e,0x3bd93aa7,0x3a4f3bce,0x26483732,0x38ec3303,0x3bff3b25
.long 0x39ed3bc3,0xb0b23564,0x395f33c6,0x3bea3b88,0x39843bb6,0xb5053303,0x39cb3444,0x3b993bce
.long 0x39133ba8,0xb78b2e46,0x3a2f34a5,0x3b0e3bf6,0x389b3b99,0xb8eca648,0x3a8a3505,0x3a4f3bff
.long 0x381d3b88,0xb9edb0b2,0x3add3564,0x395f3bea,0x37323b77,0xbac2b444,0x3b2535c2,0x38483bb6
.long 0x3c003c00,0x3c003c00,0x0,0x0,0x3bb63bce,0x3b773b99,0x34443303,0x35c23505
.long 0x3add3b3b,0x39ed3a6d,0x381d36d7,0x395f38c4,0x39843a4f,0x3732389b,0x39cb38ec,0x3b253a8a
.long 0x378b3913,0x2e4634a5,0x3b0e3a2f,0x3bf63ba8,0x33033732,0xb444a648,0x3bce3b25,0x3bb63bff
.long 0xaa4833c6,0xb8c4b564,0x3bfe3bc3,0x3a6d3b88,0xb5052648,0xbac2b8ec,0x3b993bff,0x38483a4f
.long 0xb872b23e,0xbbd9baa7,0x3aa73bd9,0x323e3872,0xba0fb67c,0xbbe2bbb6,0x393a3b50,0xb1793444
.long 0xbb3bb8c4,0xbaddbbfe,0x36d73a6d,0xb81daa48,0xbbe2ba0f,0xb8ecbb77,0x3179393a,0xba4fb5c2
.long 0xbbf6bb0e,0xb4a5ba2f,0xae46378b,0xbba8b913,0xbb77bbb6,0x2cb5b848,0xb5c23444,0xbbfabac2
.long 0xba6dbbfe,0x36d7b3c6,0xb8c42a48,0xbb3bbbc3,0xb8ecbbe2,0x39cb2cb5,0xba4fb179,0xb984bbfa
.long 0x34003400,0x34003400,0x0,0x0,0x0,0x0,0x0,0x0
.long 0x31a83400,0xb1a80000,0x31a80000,0x31a83400,0x0,0x0,0x0,0x0
.long 0x3400,0x8000b400,0x34000000,0xb4000000,0x0,0x0,0x0,0x0
.long 0xb1a83400,0x31a88000,0x31a80000,0x31a8b400,0x0,0x0,0x0,0x0
.long 0xb4003400,0xb4003400,0x0,0x0,0x0,0x0,0x0,0x0
.long 0xb1a83400,0x31a80000,0xb1a80000,0xb1a83400,0x0,0x0,0x0,0x0
.long 0x80003400,0xb400,0xb4000000,0x34000000,0x0,0x0,0x0,0x0
.long 0x31a83400,0xb1a88000,0xb1a80000,0xb1a8b400,0x0,0x0,0x0,0x0
.long 0x34003400,0x34003400,0x0,0x0,0x0,0x0,0x0,0x0
.long 0xb1a8b400,0x31a88000,0xb1a80000,0xb1a8b400,0x0,0x0,0x0,0x0
.long 0x3400,0x8000b400,0x34000000,0xb4000000,0x0,0x0,0x0,0x0
.long 0x31a8b400,0xb1a80000,0xb1a80000,0xb1a83400,0x0,0x0,0x0,0x0
.long 0xb4003400,0xb4003400,0x0,0x0,0x0,0x0,0x0,0x0
.long 0x31a8b400,0xb1a88000,0x31a80000,0x31a8b400,0x0,0x0,0x0,0x0
.long 0x80003400,0xb400,0xb4000000,0x34000000,0x0,0x0,0x0,0x0
.long 0xb1a8b400,0x31a80000,0x31a80000,0x31a83400,0x0,0x0,0x0,0x0
.long 0x0,0x0,0x0,0x0,0x34003400,0x34003400,0x0,0x0
.long 0x0,0x0,0x0,0x0,0x2e1f3364,0xb364ae1f,0x33642e1f,0x2e1f3364
.long 0x0,0x0,0x0,0x0,0xb1a831a8,0x31a8b1a8,0x31a831a8,0xb1a8b1a8
.long 0x0,0x0,0x0,0x0,0xb3642e1f,0xae1f3364,0xae1f3364,0x3364ae1f
.long 0x0,0x0,0x0,0x0,0x80000000,0x80000000,0xb4003400,0xb4003400
.long 0x0,0x0,0x0,0x0,0x3364ae1f,0x2e1fb364,0xae1f3364,0x3364ae1f
.long 0x0,0x0,0x0,0x0,0x31a8b1a8,0xb1a831a8,0x31a831a8,0xb1a8b1a8
.long 0x0,0x0,0x0,0x0,0xae1fb364,0x33642e1f,0x33642e1f,0x2e1f3364
.long 0x0,0x0,0x0,0x0,0x34003400,0x34003400,0x0,0x0
.long 0x0,0x0,0x0,0x0,0xae1fb364,0x33642e1f,0xb364ae1f,0xae1fb364
.long 0x0,0x0,0x0,0x0,0xb1a831a8,0x31a8b1a8,0x31a831a8,0xb1a8b1a8
.long 0x0,0x0,0x0,0x0,0x3364ae1f,0x2e1fb364,0x2e1fb364,0xb3642e1f
.long 0x0,0x0,0x0,0x0,0x80000000,0x80000000,0xb4003400,0xb4003400
.long 0x0,0x0,0x0,0x0,0xb3642e1f,0xae1f3364,0x2e1fb364,0xb3642e1f
.long 0x0,0x0,0x0,0x0,0x31a8b1a8,0xb1a831a8,0x31a831a8,0xb1a8b1a8
.long 0x0,0x0,0x0,0x0,0x2e1f3364,0xb364ae1f,0xb364ae1f,0xae1fb364
.long 0x80008000,0x80008000,0x34003400,0x34003400,0x0,0x0,0x0,0x0
.long 0xb1a88000,0xb1a8b400,0x31a83400,0xb1a80000,0x0,0x0,0x0,0x0
.long 0xb4008000,0x34008000,0x3400,0x8000b400,0x0,0x0,0x0,0x0
.long 0xb1a88000,0xb1a83400,0xb1a83400,0x31a88000,0x0,0x0,0x0,0x0
.long 0x80008000,0x80008000,0xb4003400,0xb4003400,0x0,0x0,0x0,0x0
.long 0x31a88000,0x31a8b400,0xb1a83400,0x31a80000,0x0,0x0,0x0,0x0
.long 0x34008000,0xb4008000,0x80003400,0xb400,0x0,0x0,0x0,0x0
.long 0x31a88000,0x31a83400,0x31a83400,0xb1a88000,0x0,0x0,0x0,0x0
.long 0x80008000,0x80008000,0x34003400,0x34003400,0x0,0x0,0x0,0x0
.long 0x31a88000,0x31a83400,0xb1a8b400,0x31a88000,0x0,0x0,0x0,0x0
.long 0xb4008000,0x34008000,0x3400,0x8000b400,0x0,0x0,0x0,0x0
.long 0x31a88000,0x31a8b400,0x31a8b400,0xb1a80000,0x0,0x0,0x0,0x0
.long 0x80008000,0x80008000,0xb4003400,0xb4003400,0x0,0x0,0x0,0x0
.long 0xb1a88000,0xb1a83400,0x31a8b400,0xb1a88000,0x0,0x0,0x0,0x0
.long 0x34008000,0xb4008000,0x80003400,0xb400,0x0,0x0,0x0,0x0
.long 0xb1a88000,0xb1a8b400,0xb1a8b400,0x31a80000,0x0,0x0,0x0,0x0
.long 0x0,0x0,0x0,0x0,0x80008000,0x80008000,0x34003400,0x34003400
.long 0x0,0x0,0x0,0x0,0xb364ae1f,0xae1fb364,0x2e1f3364,0xb364ae1f
.long 0x0,0x0,0x0,0x0,0xb1a8b1a8,0x31a831a8,0xb1a831a8,0x31a8b1a8
.long 0x0,0x0,0x0,0x0,0x2e1fb364,0xb3642e1f,0xb3642e1f,0xae1f3364
.long 0x0,0x0,0x0,0x0,0x3400b400,0x3400b400,0x80000000,0x80000000
.long 0x0,0x0,0x0,0x0,0x2e1fb364,0xb3642e1f,0x3364ae1f,0x2e1fb364
.long 0x0,0x0,0x0,0x0,0xb1a8b1a8,0x31a831a8,0x31a8b1a8,0xb1a831a8
.long 0x0,0x0,0x0,0x0,0xb364ae1f,0xae1fb364,0xae1fb364,0x33642e1f
.long 0x0,0x0,0x0,0x0,0x80008000,0x80008000,0x34003400,0x34003400
.long 0x0,0x0,0x0,0x0,0x33642e1f,0x2e1f3364,0xae1fb364,0x33642e1f
.long 0x0,0x0,0x0,0x0,0xb1a8b1a8,0x31a831a8,0xb1a831a8,0x31a8b1a8
.long 0x0,0x0,0x0,0x0,0xae1f3364,0x3364ae1f,0x3364ae1f,0x2e1fb364
.long 0x0,0x0,0x0,0x0,0x3400b400,0x3400b400,0x80000000,0x80000000
.long 0x0,0x0,0x0,0x0,0xae1f3364,0x3364ae1f,0xb3642e1f,0xae1f3364
.long 0x0,0x0,0x0,0x0,0xb1a8b1a8,0x31a831a8,0x31a8b1a8,0xb1a831a8
.long 0x0,0x0,0x0,0x0,0x33642e1f,0x2e1f3364,0x2e1f3364,0xb364ae1f
.long 0x12000,0x0,0x0,0x0,0x14800,0x0,0x0,0x0
.long 0x17000,0x0,0x0,0x0,0x19800,0x0,0x0,0x0
.long 0x1c000,0x0,0x0,0x0,0x1e800,0x0,0x0,0x0
.long 0x21000,0x0,0x0,0x0,0x23800,0x0,0x0,0x0
.long 0x26000,0x0,0x0,0x0,0x28800,0x0,0x0,0x0
.long 0x2b000,0x0,0x0,0x0,0x2d800,0x0,0x0,0x0
.long 0x30000,0x0,0x0,0x0,0x32800,0x0,0x0,0x0
.long 0x35000,0x0,0x0,0x0,0x37800,0x0,0x0,0x0
.long 0x12010,0x0,0x0,0x0,0x15c00,0x0,0x0,0x0
.long 0x18400,0x0,0x0,0x0,0x1ac00,0x0,0x0,0x0
.long 0x1d400,0x0,0x0,0x0,0x1fc00,0x0,0x0,0x0
.long 0x22400,0x0,0x0,0x0,0x24c00,0x0,0x0,0x0
.long 0x27400,0x0,0x0,0x0,0x29c00,0x0,0x0,0x0
.long 0x2c400,0x0,0x0,0x0,0x2ec00,0x0,0x0,0x0
.long 0x31400,0x0,0x0,0x0,0x33c00,0x0,0x0,0x0
.long 0x36400,0x0,0x0,0x0,0x38c00,0x0,0x0,0x0
.long 0x13400,0x0,0x0,0x0,0x23810,0x0,0x0,0x0
.long 0x21010,0x0,0x0,0x0,0x1e810,0x0,0x0,0x0
.long 0x1c010,0x0,0x0,0x0,0x19810,0x0,0x0,0x0
.long 0x17010,0x0,0x0,0x0,0x14810,0x0,0x0,0x0
.long 0x37810,0x0,0x0,0x0,0x35010,0x0,0x0,0x0
.long 0x32810,0x0,0x0,0x0,0x30010,0x0,0x0,0x0
.long 0x2d810,0x0,0x0,0x0,0x2b010,0x0,0x0,0x0
.long 0x28810,0x0,0x0,0x0,0x26010,0x0,0x0,0x0
.long 0x13410,0x0,0x0,0x0,0x24c10,0x0,0x0,0x0
.long 0x22410,0x0,0x0,0x0,0x1fc10,0x0,0x0,0x0
.long 0x1d410,0x0,0x0,0x0,0x1ac10,0x0,0x0,0x0
.long 0x18410,0x0,0x0,0x0,0x15c10,0x0,0x0,0x0
.long 0x38c10,0x0,0x0,0x0,0x36410,0x0,0x0,0x0
.long 0x33c10,0x0,0x0,0x0,0x31410,0x0,0x0,0x0
.long 0x2ec10,0x0,0x0,0x0,0x2c410,0x0,0x0,0x0
.long 0x29c10,0x0,0x0,0x0,0x27410,0x0,0x0,0x0
.long 0x3c003c00,0x3c003c00,0x0,0x0,0x3bfd3c00,0x3be93bf6,0x2aac1a48,0x30cb2e78
.long 0x3bf53c00,0x3ba43bd6,0x2eaa1e48,0x34bd326f,0x3be73c00,0x3b333ba2,0x30fd20b6,0x36f934c9
.long 0x3bd43c00,0x3a993b5a,0x32a12248,0x3887364e,0x3bbb3c00,0x39d83aff,0x342023db,0x397637c2
.long 0x3b9d3c00,0x38f63a92,0x34ed24b6,0x3a473891,0x3b793c00,0x37ee3a13,0x35b6257f,0x3af33935
.long 0x3b503bff,0x35c23984,0x367c2648,0x3b7739cb,0x3b223bff,0x32ea38e7,0x373d2711,0x3bd03a52
.long 0x3af03bff,0x2c51383d,0x37f927da,0x3bfb3ac9,0x3ab83bff,0xad4c3710,0x38582852,0x3bf93b2e
.long 0x3a7c3bff,0xb3653593,0x38b028b6,0x3bc93b80,0x3a3b3bfe,0xb5fd3408,0x3905291b,0x3b6b3bbe
.long 0x39f63bfe,0xb81230e4,0x3956297f,0x3ae33be8,0x39ad3bfe,0xb90e2aac,0x39a429e3,0x3a333bfd
.long 0x3c003c00,0x3c003c00,0x0,0x0,0x3bc13bd7,0x3b863ba6,0x33df3257,0x357034b1
.long 0x3b083b5f,0x3a273aa0,0x37a13637,0x391d387c,0x39e13a9c,0x380d3905,0x396d3881,0x3ae63a3b
.long 0x385d3996,0x31db35f1,0x3ab539ba,0x3bdd3b6e,0x35293858,0xb12e2d4c,0x3b933ab8,0x3be53bf9
.long 0x2d1a35da,0xb7cdb2d2,0x3bf93b72,0x3afc3bd1,0xb1603191,0xba0bb7d8,0x3be33be1,0x393e3af9
.long 0xb67ca648,0xbb77b9cb,0x3b503bff,0x35c23984,0xb8f1b31b,0xbc00bb28,0x3a4b3bcd,0x257f3726
.long 0xba56b693,0xbb95bbe4,0x38e23b4b,0xb51d3147,0xbb58b8ab,0xba43bbee,0x36593a7f,0xb8fbb036
.long 0xbbe6b9dc,0xb832bb46,0x31153972,0xbad0b6aa,0xbbf8bad3,0xb288b9fa,0xadb0382d,0xbbd5b951
.long 0xbb8cbb84,0x3080b828,0xb54c357c,0xbbecbad6,0xbaaabbe9,0x3780b3df,0xb86d30cb,0xbb11bbc1
.long 0x3c003c00,0x3c003c00,0x0,0x0,0x3bf73bfe,0x3bda3beb,0x2e1429e3,0x32263099
.long 0x3bdb3bf7,0x3b693bab,0x320d2de2,0x3608348d,0x3bad3bed,0x3ab13b43,0x34813067,0x386236b5
.long 0x3b6e3bdd,0x39ba3ab5,0x35f131db,0x3996385d,0x3b1d3bca,0x388c3a02,0x3753334c,0x3a953948
.long 0x3abc3bb2,0x36653930,0x3852345d,0x3b553a17,0x3a4b3b97,0x32ea3842,0x38f13511,0x3bd03ac6
.long 0x39cb3b77,0x2648367c,0x398435c2,0x3bff3b50,0x393e3b53,0xb1603451,0x3a0b3670,0x3be33bb4
.long 0x38a63b2b,0xb5ab301d,0x3a83371b,0x3b7b3bef,0x38023aff,0xb838a3db,0x3aed37c2,0x3acc3c00
.long 0x36aa3ad0,0xb972b115,0x3b463832,0x39dc3be6,0x35403a9c,0xba78b4c9,0x3b8f3881,0x38b53ba2
.long 0x33963a65,0xbb41b6ee,0x3bc638ce,0x36c13b36,0x30993a2b,0xbbc4b877,0x3beb3918,0x33ae3aa3
.long 0x3c003c00,0x3c003c00,0x0,0x0,0x3baa3bc4,0x3b673b8a,0x349933ae,0x36143558
.long 0x3aae3b14,0x39b13a37,0x38673775,0x399f3909,0x392239fa,0x3642382d,0x3a233951,0x3b5d3ad3
.long 0x364e3887,0x224832a1,0x3b5a3a99,0x3c003bd4,0x2f40359f,0xb5e5b036,0x3bf33b7d,0x3b703bee
.long 0xb1aa2f72,0xb98db748,0x3be03bf2,0x39c33b20,0xb73db004,0xbb53b9d0,0x3b223bf0,0x36703980
.long 0xb984b5c2,0xbbffbb50,0x39cb3b77,0x2648367c,0xbaf3b896,0xbb79bbfa,0x37ee3a8e,0xb5b62ce7
.long 0xbbcbba07,0xb9d4bbb9,0x33343943,0xb97bb42c,0xbbfcbb1d,0xb69eba95,0xac1f3753,0xbb49b88c
.long 0xbb80bbc9,0xa8b6b8b0,0xb5933365,0xbbffba7c,0xba62bc00,0x3587b481,0xb8d3a0b6,0xbb82bbad
.long 0xb8babbc0,0x39692b11,0xba74b3f7,0xb9e5bbfd,0xb558bb0b,0x3b3e362b,0xbb8ab796,0xb6ccbb62
.long 0x34003400,0x34003400,0x0,0x0,0x0,0x0,0x0,0x0
.long 0x315f33fe,0xb1eda248,0x31ed2248,0x315f33fe,0x0,0x0,0x0,0x0
.long 0xa64633f6,0x2646b3f6,0x33f62646,0xb3f6a646,0x0,0x0,0x0,0x0
.long 0xb26d33ea,0x30c428b2,0x30c428b2,0x326db3ea,0x0,0x0,0x0,0x0
.long 0xb3d933d9,0xb3d933d9,0xaa3e2a3e,0xaa3e2a3e,0x0,0x0,0x0,0x0
.long 0xb01d33c3,0x32ddabc6,0xb2dd2bc6,0xb01d33c3,0x0,0x0,0x0,0x0
.long 0x2ca533a8,0xaca5b3a8,0xb3a82ca5,0x33a8aca5,0x0,0x0,0x0,0x0
.long 0x333b3388,0xaed72d64,0xaed72d64,0xb33bb388,0x0,0x0,0x0,0x0
.long 0x34003400,0x34003400,0x0,0x0,0x0,0x0,0x0,0x0
.long 0xb15fb3fe,0x31ed2248,0xb1eda248,0xb15fb3fe,0x0,0x0,0x0,0x0
.long 0xa64633f6,0x2646b3f6,0x33f62646,0xb3f6a646,0x0,0x0,0x0,0x0
.long 0x326db3ea,0xb0c4a8b2,0xb0c4a8b2,0xb26d33ea,0x0,0x0,0x0,0x0
.long 0xb3d933d9,0xb3d933d9,0xaa3e2a3e,0xaa3e2a3e,0x0,0x0,0x0,0x0
.long 0x301db3c3,0xb2dd2bc6,0x32ddabc6,0x301db3c3,0x0,0x0,0x0,0x0
.long 0x2ca533a8,0xaca5b3a8,0xb3a82ca5,0x33a8aca5,0x0,0x0,0x0,0x0
.long 0xb33bb388,0x2ed7ad64,0x2ed7ad64,0x333b3388,0x0,0x0,0x0,0x0
.long 0x0,0x0,0x0,0x0,0x34003400,0x34003400,0x0,0x0
.long 0x0,0x0,0x0,0x0,0x224831ed,0xb3feb15f,0x33fe315f,0x224831ed
.long 0x0,0x0,0x0,0x0,0xb3f62646,0x33f6a646,0x264633f6,0xa646b3f6
.long 0x0,0x0,0x0,0x0,0xa8b2b0c4,0xb3ea326d,0xb3ea326d,0x28b230c4
.long 0x0,0x0,0x0,0x0,0x33d9b3d9,0x33d9b3d9,0xaa3e2a3e,0xaa3e2a3e
.long 0x0,0x0,0x0,0x0,0x2bc6b2dd,0xb3c3301d,0x33c3b01d,0x2bc6b2dd
.long 0x0,0x0,0x0,0x0,0xb3a8aca5,0x33a82ca5,0x2ca5b3a8,0xaca533a8
.long 0x0,0x0,0x0,0x0,0xad642ed7,0xb388b33b,0xb388b33b,0x2d64aed7
.long 0x0,0x0,0x0,0x0,0x34003400,0x34003400,0x0,0x0
.long 0x0,0x0,0x0,0x0,0xa248b1ed,0x33fe315f,0xb3feb15f,0xa248b1ed
.long 0x0,0x0,0x0,0x0,0xb3f62646,0x33f6a646,0x264633f6,0xa646b3f6
.long 0x0,0x0,0x0,0x0,0x28b230c4,0x33eab26d,0x33eab26d,0xa8b2b0c4
.long 0x0,0x0,0x0,0x0,0x33d9b3d9,0x33d9b3d9,0xaa3e2a3e,0xaa3e2a3e
.long 0x0,0x0,0x0,0x0,0xabc632dd,0x33c3b01d,0xb3c3301d,0xabc632dd
.long 0x0,0x0,0x0,0x0,0xb3a8aca5,0x33a82ca5,0x2ca5b3a8,0xaca533a8
.long 0x0,0x0,0x0,0x0,0x2d64aed7,0x3388333b,0x3388333b,0xad642ed7
.long 0x80008000,0x80008000,0x34003400,0x34003400,0x0,0x0,0x0,0x0
.long 0xb1eda248,0xb15fb3fe,0x315f33fe,0xb1eda248,0x0,0x0,0x0,0x0
.long 0xb3f6a646,0x33f62646,0xa64633f6,0x2646b3f6,0x0,0x0,0x0,0x0
.long 0xb0c4a8b2,0xb26d33ea,0xb26d33ea,0x30c428b2,0x0,0x0,0x0,0x0
.long 0x2a3eaa3e,0x2a3eaa3e,0xb3d933d9,0xb3d933d9,0x0,0x0,0x0,0x0
.long 0x32ddabc6,0x301db3c3,0xb01d33c3,0x32ddabc6,0x0,0x0,0x0,0x0
.long 0x33a8aca5,0xb3a82ca5,0x2ca533a8,0xaca5b3a8,0x0,0x0,0x0,0x0
.long 0x2ed7ad64,0x333b3388,0x333b3388,0xaed72d64,0x0,0x0,0x0,0x0
.long 0x80008000,0x80008000,0x34003400,0x34003400,0x0,0x0,0x0,0x0
.long 0x31ed2248,0x315f33fe,0xb15fb3fe,0x31ed2248,0x0,0x0,0x0,0x0
.long 0xb3f6a646,0x33f62646,0xa64633f6,0x2646b3f6,0x0,0x0,0x0,0x0
.long 0x30c428b2,0x326db3ea,0x326db3ea,0xb0c4a8b2,0x0,0x0,0x0,0x0
.long 0x2a3eaa3e,0x2a3eaa3e,0xb3d933d9,0xb3d933d9,0x0,0x0,0x0,0x0
.long 0xb2dd2bc6,0xb01d33c3,0x301db3c3,0xb2dd2bc6,0x0,0x0,0x0,0x0
.long 0x33a8aca5,0xb3a82ca5,0x2ca533a8,0xaca5b3a8,0x0,0x0,0x0,0x0
.long 0xaed72d64,0xb33bb388,0xb33bb388,0x2ed7ad64,0x0,0x0,0x0,0x0
.long 0x0,0x0,0x0,0x0,0x80008000,0x80008000,0x34003400,0x34003400
.long 0x0,0x0,0x0,0x0,0xb3feb15f,0xa248b1ed,0x224831ed,0xb3feb15f
.long 0x0,0x0,0x0,0x0,0xa646b3f6,0x264633f6,0xb3f62646,0x33f6a646
.long 0x0,0x0,0x0,0x0,0x33eab26d,0xa8b2b0c4,0xa8b2b0c4,0xb3ea326d
.long 0x0,0x0,0x0,0x0,0x2a3eaa3e,0x2a3eaa3e,0x33d9b3d9,0x33d9b3d9
.long 0x0,0x0,0x0,0x0,0xb3c3301d,0xabc632dd,0x2bc6b2dd,0xb3c3301d
.long 0x0,0x0,0x0,0x0,0xaca533a8,0x2ca5b3a8,0xb3a8aca5,0x33a82ca5
.long 0x0,0x0,0x0,0x0,0x3388333b,0xad642ed7,0xad642ed7,0xb388b33b
.long 0x0,0x0,0x0,0x0,0x80008000,0x80008000,0x34003400,0x34003400
.long 0x0,0x0,0x0,0x0,0x33fe315f,0x224831ed,0xa248b1ed,0x33fe315f
.long 0x0,0x0,0x0,0x0,0xa646b3f6,0x264633f6,0xb3f62646,0x33f6a646
.long 0x0,0x0,0x0,0x0,0xb3ea326d,0x28b230c4,0x28b230c4,0x33eab26d
.long 0x0,0x0,0x0,0x0,0x2a3eaa3e,0x2a3eaa3e,0x33d9b3d9,0x33d9b3d9
.long 0x0,0x0,0x0,0x0,0x33c3b01d,0x2bc6b2dd,0xabc632dd,0x33c3b01d
.long 0x0,0x0,0x0,0x0,0xaca533a8,0x2ca5b3a8,0xb3a8aca5,0x33a82ca5
.long 0x0,0x0,0x0,0x0,0xb388b33b,0x2d64aed7,0x2d64aed7,0x3388333b
.long 0x3a000,0x0,0x0,0x0,0x3c800,0x0,0x0,0x0
.long 0x3f000,0x0,0x0,0x0,0x41800,0x0,0x0,0x0
.long 0x44000,0x0,0x0,0x0,0x46800,0x0,0x0,0x0
.long 0x49000,0x0,0x0,0x0,0x4b800,0x0,0x0,0x0
.long 0x4e000,0x0,0x0,0x0,0x50800,0x0,0x0,0x0
.long 0x53000,0x0,0x0,0x0,0x55800,0x0,0x0,0x0
.long 0x58000,0x0,0x0,0x0,0x5a800,0x0,0x0,0x0
.long 0x5d000,0x0,0x0,0x0,0x5f800,0x0,0x0,0x0
.long 0x3b400,0x0,0x0,0x0,0x3dc00,0x0,0x0,0x0
.long 0x40400,0x0,0x0,0x0,0x42c00,0x0,0x0,0x0
.long 0x45400,0x0,0x0,0x0,0x47c00,0x0,0x0,0x0
.long 0x4a400,0x0,0x0,0x0,0x4cc00,0x0,0x0,0x0
.long 0x4f400,0x0,0x0,0x0,0x51c00,0x0,0x0,0x0
.long 0x54400,0x0,0x0,0x0,0x56c00,0x0,0x0,0x0
.long 0x59400,0x0,0x0,0x0,0x5bc00,0x0,0x0,0x0
.long 0x5e400,0x0,0x0,0x0,0x60c00,0x0,0x0,0x0
.long 0x5f810,0x0,0x0,0x0,0x5d010,0x0,0x0,0x0
.long 0x5a810,0x0,0x0,0x0,0x58010,0x0,0x0,0x0
.long 0x55810,0x0,0x0,0x0,0x53010,0x0,0x0,0x0
.long 0x50810,0x0,0x0,0x0,0x4e010,0x0,0x0,0x0
.long 0x4b810,0x0,0x0,0x0,0x49010,0x0,0x0,0x0
.long 0x46810,0x0,0x0,0x0,0x44010,0x0,0x0,0x0
.long 0x41810,0x0,0x0,0x0,0x3f010,0x0,0x0,0x0
.long 0x3c810,0x0,0x0,0x0,0x3a010,0x0,0x0,0x0
.long 0x60c10,0x0,0x0,0x0,0x5e410,0x0,0x0,0x0
.long 0x5bc10,0x0,0x0,0x0,0x59410,0x0,0x0,0x0
.long 0x56c10,0x0,0x0,0x0,0x54410,0x0,0x0,0x0
.long 0x51c10,0x0,0x0,0x0,0x4f410,0x0,0x0,0x0
.long 0x4cc10,0x0,0x0,0x0,0x4a410,0x0,0x0,0x0
.long 0x47c10,0x0,0x0,0x0,0x45410,0x0,0x0,0x0
.long 0x42c10,0x0,0x0,0x0,0x40410,0x0,0x0,0x0
.long 0x3dc10,0x0,0x0,0x0,0x3b410,0x0,0x0,0x0
.long 0x3c003c00,0x3c003c00,0x0,0x0,0x3bfd3c00,0x3be83bf5,0x2b111e48,0x30e42eaa
.long 0x3bf43c00,0x3ba03bd4,0x2f0e2248,0x34d532a1,0x3be43c00,0x3b2b3b9d,0x314724b6,0x371b34ed
.long 0x3bce3bff,0x3a8a3b50,0x33032648,0x389b367c,0x3bb23bff,0x39c33af0,0x345d27da,0x398d37f9
.long 0x3b913bff,0x38d83a7c,0x353428b6,0x3a5e38b0,0x3b693bfe,0x37a139f6,0x3608297f,0x3b083956
.long 0x3b3b3bfe,0x3564395f,0x36d72a48,0x3b8839ed,0x3b083bfd,0x320d38ba,0x37a12b11,0x3bdb3a74
.long 0x3ad03bfc,0x28b63807,0x38322bd9,0x3bff3ae9,0x3a923bfb,0xaf723693,0x38912c51,0x3bf23b4b
.long 0x3a4f3bfa,0xb4443505,0x38ec2cb5,0x3bb63b99,0x3a073bf9,0xb69332d2,0x39432d1a,0x3b4b3bd1
.long 0x39ba3bf8,0xb85d2f0e,0x39962d7e,0x3ab53bf4,0x39693bf7,0xb9561e48,0x39e52de2,0x39f63c00
.long 0x3c003c00,0x3c003c00,0x0,0x0,0x3bc03bd6,0x3b843ba4,0x33f7326f,0x357c34bd
.long 0x3b023b5a,0x3a1f3a99,0x37b7364e,0x39273887,0x39d43a92,0x37f938f6,0x397b3891,0x3af03a47
.long 0x38483984,0x317935c2,0x3ac239cb,0x3be23b77,0x34ed383d,0xb1aa2c51,0x3b9d3ac9,0x3be03bfb
.long 0x2bd93593,0xb807b365,0x3bfc3b80,0x3ae93bc9,0xb20d30e4,0xba27b812,0x3bdb3be8,0x391d3ae3
.long 0xb6d7aa48,0xbb88b9ed,0x3b3b3bfe,0x3564395f,0xb91db3f7,0xbc00bb41,0x3a273bc0,0x9e4836c1
.long 0xba7cb705,0xbb80bbed,0x38b03b30,0xb593304e,0xbb72b8e2,0xba17bbe4,0x35da3a56,0xb930b147
.long 0xbbf1ba0f,0xb7e3bb25,0x2fd6393a,0xbaf6b732,0xbbefbafc,0xb147b9c3,0xb01d37cd,0xbbe4b98d
.long 0xbb6ebba0,0x31dbb7b7,0xb5f134d5,0xbbddbb02,0xba74bbf5,0x3812b26f,0xb8ba2eaa,0xbae3bbd6
.long 0x3c003c00,0x3c003c00,0x0,0x0,0x3bf73bfe,0x3bdb3bec,0x2de2297f,0x320d3080
.long 0x3bdd3bf8,0x3b6e3baf,0x31db2d7e,0x35f13475,0x3bb23bef,0x3abc3b4b,0x345d301d,0x38523693
.long 0x3b773be2,0x39cb3ac2,0x35c23179,0x39843848,0x3b2b3bd1,0x38a63a17,0x371b32d2,0x3a833930
.long 0x3ad03bbc,0x36aa394d,0x38323414,0x3b4639fe,0x3a653ba4,0x33963867,0x38ce34bd,0x3bc63aae
.long 0x39ed3b88,0x2a4836d7,0x395f3564,0x3bfe3b3b,0x39693b69,0xb08034bd,0x39e53608,0x3bec3ba4
.long 0x38d83b46,0xb5343115,0x3a5e36aa,0x3b913be6,0x383d3b20,0xb7f924b6,0x3ac93748,0x3af03c00
.long 0x37323af6,0xb93aafd6,0x3b2537e3,0x3a0f3bf1,0x35da3ac9,0xba47b42c,0x3b72383d,0x38f63bb9
.long 0x34753a99,0xbb1ab64e,0x3baf3887,0x375e3b5a,0x320d3a65,0xbbabb828,0x3bdb38ce,0x348d3ad6
.long 0x3c003c00,0x3c003c00,0x0,0x0,0x3bab3bc6,0x3b693b8c,0x348d3396,0x3608354c
.long 0x3ab53b1a,0x39ba3a3f,0x385d375e,0x39963900,0x39303a07,0x3665383d,0x3a173943,0x3b553ac9
.long 0x367c389b,0x26483303,0x3b503a8a,0x3bff3bce,0x301d35da,0xb5abaf72,0x3bef3b72,0x3b7b3bf2
.long 0xb115304e,0xb972b705,0x3be63bed,0x39dc3b30,0xb6eeaeaa,0xbb41b9b1,0x3b363bf5,0x36c1399f
.long 0xb95fb564,0xbbfebb3b,0x39ed3b88,0x2a4836d7,0xbad6b867,0xbb8cbbf5,0x38283aae,0xb54c2eaa
.long 0xbbbcb9dc,0xb9febbc9,0x34143972,0xb94db365,0xbbffbafc,0xb71bbabc,0xa7da37cd,0xbb2bb852
.long 0xbb99bbb6,0xacb5b8ec,0xb5053444,0xbbfaba4f,0xba92bbff,0x34edb51d,0xb89127da,0xbb9dbb95
.long 0xb900bbd4,0x39272248,0xba3fb2a1,0xba1fbc00,0xb608bb36,0x3b14357c,0xbb69b6ee,0xb775bb84
.long 0x34003400,0x34003400,0x0,0x0,0x0,0x0,0x0,0x0
.long 0x311333f6,0xb22fa646,0x322f2646,0x311333f6,0x0,0x0,0x0,0x0
.long 0xaa3e33d9,0x2a3eb3d9,0x33d92a3e,0xb3d9aa3e,0x0,0x0,0x0,0x0
.long 0xb30e33a8,0x2f8b2ca5,0x2f8b2ca5,0x330eb3a8,0x0,0x0,0x0,0x0
.long 0xb3643364,0xb3643364,0xae1f2e1f,0xae1f2e1f,0x0,0x0,0x0,0x0
.long 0xaca5330e,0x33a8af8b,0xb3a82f8b,0xaca5330e,0x0,0x0,0x0,0x0
.long 0x307232a7,0xb072b2a7,0xb2a73072,0x32a7b072,0x0,0x0,0x0,0x0
.long 0x33f6322f,0xa6463113,0xa6463113,0xb3f6b22f,0x0,0x0,0x0,0x0
.long 0x34003400,0x34003400,0x0,0x0,0x0,0x0,0x0,0x0
.long 0xb113b3f6,0x322f2646,0xb22fa646,0xb113b3f6,0x0,0x0,0x0,0x0
.long 0xaa3e33d9,0x2a3eb3d9,0x33d92a3e,0xb3d9aa3e,0x0,0x0,0x0,0x0
.long 0x330eb3a8,0xaf8baca5,0xaf8baca5,0xb30e33a8,0x0,0x0,0x0,0x0
.long 0xb3643364,0xb3643364,0xae1f2e1f,0xae1f2e1f,0x0,0x0,0x0,0x0
.long 0x2ca5b30e,0xb3a82f8b,0x33a8af8b,0x2ca5b30e,0x0,0x0,0x0,0x0
.long 0x307232a7,0xb072b2a7,0xb2a73072,0x32a7b072,0x0,0x0,0x0,0x0
.long 0xb3f6b22f,0x2646b113,0x2646b113,0x33f6322f,0x0,0x0,0x0,0x0
.long 0x0,0x0,0x0,0x0,0x34003400,0x34003400,0x0,0x0
.long 0x0,0x0,0x0,0x0,0x2646322f,0xb3f6b113,0x33f63113,0x2646322f
.long 0x0,0x0,0x0,0x0,0xb3d92a3e,0x33d9aa3e,0x2a3e33d9,0xaa3eb3d9
.long 0x0,0x0,0x0,0x0,0xaca5af8b,0xb3a8330e,0xb3a8330e,0x2ca52f8b
.long 0x0,0x0,0x0,0x0,0x3364b364,0x3364b364,0xae1f2e1f,0xae1f2e1f
.long 0x0,0x0,0x0,0x0,0x2f8bb3a8,0xb30e2ca5,0x330eaca5,0x2f8bb3a8
.long 0x0,0x0,0x0,0x0,0xb2a7b072,0x32a73072,0x3072b2a7,0xb07232a7
.long 0x0,0x0,0x0,0x0,0xb1132646,0xb22fb3f6,0xb22fb3f6,0x3113a646
.long 0x0,0x0,0x0,0x0,0x34003400,0x34003400,0x0,0x0
.long 0x0,0x0,0x0,0x0,0xa646b22f,0x33f63113,0xb3f6b113,0xa646b22f
.long 0x0,0x0,0x0,0x0,0xb3d92a3e,0x33d9aa3e,0x2a3e33d9,0xaa3eb3d9
.long 0x0,0x0,0x0,0x0,0x2ca52f8b,0x33a8b30e,0x33a8b30e,0xaca5af8b
.long 0x0,0x0,0x0,0x0,0x3364b364,0x3364b364,0xae1f2e1f,0xae1f2e1f
.long 0x0,0x0,0x0,0x0,0xaf8b33a8,0x330eaca5,0xb30e2ca5,0xaf8b33a8
.long 0x0,0x0,0x0,0x0,0xb2a7b072,0x32a73072,0x3072b2a7,0xb07232a7
.long 0x0,0x0,0x0,0x0,0x3113a646,0x322f33f6,0x322f33f6,0xb1132646
.long 0x80008000,0x80008000,0x34003400,0x34003400,0x0,0x0,0x0,0x0
.long 0xb22fa646,0xb113b3f6,0x311333f6,0xb22fa646,0x0,0x0,0x0,0x0
.long 0xb3d9aa3e,0x33d92a3e,0xaa3e33d9,0x2a3eb3d9,0x0,0x0,0x0,0x0
.long 0xaf8baca5,0xb30e33a8,0xb30e33a8,0x2f8b2ca5,0x0,0x0,0x0,0x0
.long 0x2e1fae1f,0x2e1fae1f,0xb3643364,0xb3643364,0x0,0x0,0x0,0x0
.long 0x33a8af8b,0x2ca5b30e,0xaca5330e,0x33a8af8b,0x0,0x0,0x0,0x0
.long 0x32a7b072,0xb2a73072,0x307232a7,0xb072b2a7,0x0,0x0,0x0,0x0
.long 0x2646b113,0x33f6322f,0x33f6322f,0xa6463113,0x0,0x0,0x0,0x0
.long 0x80008000,0x80008000,0x34003400,0x34003400,0x0,0x0,0x0,0x0
.long 0x322f2646,0x311333f6,0xb113b3f6,0x322f2646,0x0,0x0,0x0,0x0
.long 0xb3d9aa3e,0x33d92a3e,0xaa3e33d9,0x2a3eb3d9,0x0,0x0,0x0,0x0
.long 0x2f8b2ca5,0x330eb3a8,0x330eb3a8,0xaf8baca5,0x0,0x0,0x0,0x0
.long 0x2e1fae1f,0x2e1fae1f,0xb3643364,0xb3643364,0x0,0x0,0x0,0x0
.long 0xb3a82f8b,0xaca5330e,0x2ca5b30e,0xb3a82f8b,0x0,0x0,0x0,0x0
.long 0x32a7b072,0xb2a73072,0x307232a7,0xb072b2a7,0x0,0x0,0x0,0x0
.long 0xa6463113,0xb3f6b22f,0xb3f6b22f,0x2646b113,0x0,0x0,0x0,0x0
.long 0x0,0x0,0x0,0x0,0x80008000,0x80008000,0x34003400,0x34003400
.long 0x0,0x0,0x0,0x0,0xb3f6b113,0xa646b22f,0x2646322f,0xb3f6b113
.long 0x0,0x0,0x0,0x0,0xaa3eb3d9,0x2a3e33d9,0xb3d92a3e,0x33d9aa3e
.long 0x0,0x0,0x0,0x0,0x33a8b30e,0xaca5af8b,0xaca5af8b,0xb3a8330e
.long 0x0,0x0,0x0,0x0,0x2e1fae1f,0x2e1fae1f,0x3364b364,0x3364b364
.long 0x0,0x0,0x0,0x0,0xb30e2ca5,0xaf8b33a8,0x2f8bb3a8,0xb30e2ca5
.long 0x0,0x0,0x0,0x0,0xb07232a7,0x3072b2a7,0xb2a7b072,0x32a73072
.long 0x0,0x0,0x0,0x0,0x322f33f6,0xb1132646,0xb1132646,0xb22fb3f6
.long 0x0,0x0,0x0,0x0,0x80008000,0x80008000,0x34003400,0x34003400
.long 0x0,0x0,0x0,0x0,0x33f63113,0x2646322f,0xa646b22f,0x33f63113
.long 0x0,0x0,0x0,0x0,0xaa3eb3d9,0x2a3e33d9,0xb3d92a3e,0x33d9aa3e
.long 0x0,0x0,0x0,0x0,0xb3a8330e,0x2ca52f8b,0x2ca52f8b,0x33a8b30e
.long 0x0,0x0,0x0,0x0,0x2e1fae1f,0x2e1fae1f,0x3364b364,0x3364b364
.long 0x0,0x0,0x0,0x0,0x330eaca5,0x2f8bb3a8,0xaf8b33a8,0x330eaca5
.long 0x0,0x0,0x0,0x0,0xb07232a7,0x3072b2a7,0xb2a7b072,0x32a73072
.long 0x0,0x0,0x0,0x0,0xb22fb3f6,0x3113a646,0x3113a646,0x322f33f6
.long 0x62000,0x0,0x0,0x0,0x64800,0x0,0x0,0x0
.long 0x67000,0x0,0x0,0x0,0x69800,0x0,0x0,0x0
.long 0x6c000,0x0,0x0,0x0,0x6e800,0x0,0x0,0x0
.long 0x71000,0x0,0x0,0x0,0x73800,0x0,0x0,0x0
.long 0x76000,0x0,0x0,0x0,0x78800,0x0,0x0,0x0
.long 0x7b000,0x0,0x0,0x0,0x7d800,0x0,0x0,0x0
.long 0x80000,0x0,0x0,0x0,0x82800,0x0,0x0,0x0
.long 0x85000,0x0,0x0,0x0,0x87800,0x0,0x0,0x0
.long 0x63400,0x0,0x0,0x0,0x65c00,0x0,0x0,0x0
.long 0x68400,0x0,0x0,0x0,0x6ac00,0x0,0x0,0x0
.long 0x6d400,0x0,0x0,0x0,0x6fc00,0x0,0x0,0x0
.long 0x72400,0x0,0x0,0x0,0x74c00,0x0,0x0,0x0
.long 0x77400,0x0,0x0,0x0,0x79c00,0x0,0x0,0x0
.long 0x7c400,0x0,0x0,0x0,0x7ec00,0x0,0x0,0x0
.long 0x81400,0x0,0x0,0x0,0x83c00,0x0,0x0,0x0
.long 0x86400,0x0,0x0,0x0,0x88c00,0x0,0x0,0x0
.long 0x87810,0x0,0x0,0x0,0x85010,0x0,0x0,0x0
.long 0x82810,0x0,0x0,0x0,0x80010,0x0,0x0,0x0
.long 0x7d810,0x0,0x0,0x0,0x7b010,0x0,0x0,0x0
.long 0x78810,0x0,0x0,0x0,0x76010,0x0,0x0,0x0
.long 0x73810,0x0,0x0,0x0,0x71010,0x0,0x0,0x0
.long 0x6e810,0x0,0x0,0x0,0x6c010,0x0,0x0,0x0
.long 0x69810,0x0,0x0,0x0,0x67010,0x0,0x0,0x0
.long 0x64810,0x0,0x0,0x0,0x62010,0x0,0x0,0x0
.long 0x88c10,0x0,0x0,0x0,0x86410,0x0,0x0,0x0
.long 0x83c10,0x0,0x0,0x0,0x81410,0x0,0x0,0x0
.long 0x7ec10,0x0,0x0,0x0,0x7c410,0x0,0x0,0x0
.long 0x79c10,0x0,0x0,0x0,0x77410,0x0,0x0,0x0
.long 0x74c10,0x0,0x0,0x0,0x72410,0x0,0x0,0x0
.long 0x6fc10,0x0,0x0,0x0,0x6d410,0x0,0x0,0x0
.long 0x6ac10,0x0,0x0,0x0,0x68410,0x0,0x0,0x0
.long 0x65c10,0x0,0x0,0x0,0x63410,0x0,0x0,0x0
.long 0x3c003c00,0x3c003c00,0x0,0x0,0x3bfd3c00,0x3be73bf4,0x2b7520b6,0x30fd2edc
.long 0x3bf23c00,0x3b9d3bd1,0x2f7224b6,0x34ed32d2,0x3be13bff,0x3b223b97,0x31912711,0x373d3511
.long 0x3bc93bff,0x3a7c3b46,0x336528b6,0x38b036aa,0x3baa3bfe,0x39ad3ae0,0x349929e3,0x39a43817
.long 0x3b843bfd,0x38ba3a65,0x357c2b11,0x3a7438ce,0x3b583bfc,0x375339d8,0x36592c1f,0x3b1d3976
.long 0x3b253bfa,0x3505393a,0x37322cb5,0x3b993a0f,0x3aed3bf9,0x312e388c,0x38022d4c,0x3be53a95
.long 0x3aae3bf7,0x1e4837a1,0x38672de2,0x3c003b08,0x3a693bf6,0xb0cb3614,0x38c92e78,0x3be93b67
.long 0x3a1f3bf4,0xb4d53475,0x39272f0e,0x3ba03baf,0x39d03bf1,0xb7263191,0x39802fa4,0x3b283be1
.long 0x397b3bef,0xb8a62c51,0x39d4301d,0x3a833bfb,0x39223bed,0xb99ba91b,0x3a233067,0x39b53bfe
.long 0x3c003c00,0x3c003c00,0x0,0x0,0x3bbe3bd5,0x3b823ba2,0x34083288,0x358734c9
.long 0x3afc3b55,0x3a173a92,0x37cd3665,0x39303891,0x39c73a87,0x37d838e7,0x398938a0,0x3af93a52
.long 0x38323972,0x31153593,0x3ad039dc,0x3be63b80,0x34b13822,0xb2262aac,0x3ba63ad9,0x3bda3bfd
.long 0x297f354c,0xb828b3f7,0x3bfe3b8c,0x3ad63bc0,0xb2b93036,0xba43b838,0x3bd23bee,0x38fb3acc
.long 0xb732acb5,0xbb99ba0f,0x3b253bfa,0x3505393a,0xb948b469,0xbbffbb58,0x3a023bb1,0xa8523659
.long 0xbaa0b775,0xbb69bbf5,0x387c3b14,0xb6082eaa,0xbb8ab918,0xb9e9bbd7,0x35583a2b,0xb964b257
.long 0xbbf8ba3f,0xb75ebb02,0x2d7e3900,0xbb1ab7b7,0xbbe3bb22,0xb004b989,0xb160373d,0xbbf0b9c7
.long 0xbb4bbbb9,0x3334b71b,0xb693342c,0xbbcbbb2b,0xba3bbbfd,0x3862b0fd,0xb9052b75,0xbab1bbe7
.long 0x3c003c00,0x3c003c00,0x0,0x0,0x3bf83bfe,0x3bdc3bed,0x2db0291b,0x31f43067
.long 0x3be03bf9,0x3b723bb2,0x31aa2d1a,0x35da345d,0x3bb73bf1,0x3ac63b53,0x34382fa4,0x38423670
.long 0x3b803be6,0x39dc3ad0,0x35933115,0x39723832,0x3b393bd7,0x38bf3a2b,0x36e33257,0x3a713918
.long 0x3ae33bc6,0x36ee3969,0x38123396,0x3b3639e5,0x3a7f3bb1,0x3420388c,0x38ab3469,0x3bbb3a95
.long 0x3a0f3b99,0x2cb53732,0x393a3505,0x3bfa3b25,0x39923b7d,0xaf403529,0x39be359f,0x3bf33b93
.long 0x39093b5f,0xb4bd320d,0x3a373637,0x3ba43bdb,0x38773b3e,0xb7802aac,0x3aa336cc,0x3b113bfd
.long 0x37b73b1a,0xb900ad7e,0x3b02375e,0x3a3f3bf8,0x36703af3,0xba13b31b,0x3b5337ee,0x39353bcd
.long 0x351d3ac9,0xbaf0b5ab,0x3b95383d,0x37f93b7b,0x337d3a9c,0xbb8fb7ac,0x3bc73881,0x35403b05
.long 0x3c003c00,0x3c003c00,0x0,0x0,0x3bad3bc7,0x3b6b3b8f,0x3481337d,0x35fd3540
.long 0x3abc3b20,0x39c33a47,0x38523748,0x398d38f6,0x393e3a13,0x3687384d,0x3a0b3935,0x3b4e3abf
.long 0x36aa38b0,0x28b63365,0x3b463a7c,0x3bff3bc9,0x30993614,0xb570ae78,0x3beb3b67,0x3b863bf6
.long 0xb08030e4,0xb956b6c1,0x3bec3be8,0x39f63b41,0xb69ead4c,0xbb2eb992,0x3b493bf9,0x371039be
.long 0xb93ab505,0xbbfabb25,0x3a0f3b99,0x2cb53732,0xbab8b838,0xbb9ebbee,0x38583acc,0xb4e13036
.long 0xbbabb9b1,0xba27bbd6,0x348d399f,0xb91db26f,0xbc00bad9,0xb796bae0,0x1a483822,0xbb0bb817
.long 0xbbafbba0,0xaf0eb927,0xb47534d5,0xbbf4ba1f,0xbabfbbfb,0x3451b5b6,0xb84d2c83,0xbbb4bb79
.long 0xb943bbe4,0x38e2a7da,0xba07b147,0xba56bbff,0xb6b5bb5d,0x3ae634c9,0xbb43b642,0xb80dbba2
.long 0x34003400,0x34003400,0x0,0x0,0x0,0x0,0x0,0x0
.long 0x30c433ea,0xb26da8b2,0x326d28b2,0x30c433ea,0x0,0x0,0x0,0x0
.long 0xaca533a8,0x2ca5b3a8,0x33a82ca5,0xb3a8aca5,0x0,0x0,0x0,0x0
.long 0xb388333b,0x2d642ed7,0x2d642ed7,0x3388b33b,0x0,0x0,0x0,0x0
.long 0xb2a732a7,0xb2a732a7,0xb0723072,0xb0723072,0x0,0x0,0x0,0x0
.long 0xa24831ed,0x33feb15f,0xb3fe315f,0xa24831ed,0x0,0x0,0x0,0x0
.long 0x322f3113,0xb22fb113,0xb113322f,0x3113b22f,0x0,0x0,0x0,0x0
.long 0x33c3301d,0x2bc632dd,0x2bc632dd,0xb3c3b01d,0x0,0x0,0x0,0x0
.long 0x34003400,0x34003400,0x0,0x0,0x0,0x0,0x0,0x0
.long 0xb0c4b3ea,0x326d28b2,0xb26da8b2,0xb0c4b3ea,0x0,0x0,0x0,0x0
.long 0xaca533a8,0x2ca5b3a8,0x33a82ca5,0xb3a8aca5,0x0,0x0,0x0,0x0
.long 0x3388b33b,0xad64aed7,0xad64aed7,0xb388333b,0x0,0x0,0x0,0x0
.long 0xb2a732a7,0xb2a732a7,0xb0723072,0xb0723072,0x0,0x0,0x0,0x0
.long 0x2248b1ed,0xb3fe315f,0x33feb15f,0x2248b1ed,0x0,0x0,0x0,0x0
.long 0x322f3113,0xb22fb113,0xb113322f,0x3113b22f,0x0,0x0,0x0,0x0
.long 0xb3c3b01d,0xabc6b2dd,0xabc6b2dd,0x33c3301d,0x0,0x0,0x0,0x0
.long 0x0,0x0,0x0,0x0,0x34003400,0x34003400,0x0,0x0
.long 0x0,0x0,0x0,0x0,0x28b2326d,0xb3eab0c4,0x33ea30c4,0x28b2326d
.long 0x0,0x0,0x0,0x0,0xb3a82ca5,0x33a8aca5,0x2ca533a8,0xaca5b3a8
.long 0x0,0x0,0x0,0x0,0xaed7ad64,0xb33b3388,0xb33b3388,0x2ed72d64
.long 0x0,0x0,0x0,0x0,0x32a7b2a7,0x32a7b2a7,0xb0723072,0xb0723072
.long 0x0,0x0,0x0,0x0,0x315fb3fe,0xb1ed2248,0x31eda248,0x315fb3fe
.long 0x0,0x0,0x0,0x0,0xb113b22f,0x3113322f,0x322fb113,0xb22f3113
.long 0x0,0x0,0x0,0x0,0xb2ddabc6,0xb01db3c3,0xb01db3c3,0x32dd2bc6
.long 0x0,0x0,0x0,0x0,0x34003400,0x34003400,0x0,0x0
.long 0x0,0x0,0x0,0x0,0xa8b2b26d,0x33ea30c4,0xb3eab0c4,0xa8b2b26d
.long 0x0,0x0,0x0,0x0,0xb3a82ca5,0x33a8aca5,0x2ca533a8,0xaca5b3a8
.long 0x0,0x0,0x0,0x0,0x2ed72d64,0x333bb388,0x333bb388,0xaed7ad64
.long 0x0,0x0,0x0,0x0,0x32a7b2a7,0x32a7b2a7,0xb0723072,0xb0723072
.long 0x0,0x0,0x0,0x0,0xb15f33fe,0x31eda248,0xb1ed2248,0xb15f33fe
.long 0x0,0x0,0x0,0x0,0xb113b22f,0x3113322f,0x322fb113,0xb22f3113
.long 0x0,0x0,0x0,0x0,0x32dd2bc6,0x301d33c3,0x301d33c3,0xb2ddabc6
.long 0x80008000,0x80008000,0x34003400,0x34003400,0x0,0x0,0x0,0x0
.long 0xb26da8b2,0xb0c4b3ea,0x30c433ea,0xb26da8b2,0x0,0x0,0x0,0x0
.long 0xb3a8aca5,0x33a82ca5,0xaca533a8,0x2ca5b3a8,0x0,0x0,0x0,0x0
.long 0xad64aed7,0xb388333b,0xb388333b,0x2d642ed7,0x0,0x0,0x0,0x0
.long 0x3072b072,0x3072b072,0xb2a732a7,0xb2a732a7,0x0,0x0,0x0,0x0
.long 0x33feb15f,0x2248b1ed,0xa24831ed,0x33feb15f,0x0,0x0,0x0,0x0
.long 0x3113b22f,0xb113322f,0x322f3113,0xb22fb113,0x0,0x0,0x0,0x0
.long 0xabc6b2dd,0x33c3301d,0x33c3301d,0x2bc632dd,0x0,0x0,0x0,0x0
.long 0x80008000,0x80008000,0x34003400,0x34003400,0x0,0x0,0x0,0x0
.long 0x326d28b2,0x30c433ea,0xb0c4b3ea,0x326d28b2,0x0,0x0,0x0,0x0
.long 0xb3a8aca5,0x33a82ca5,0xaca533a8,0x2ca5b3a8,0x0,0x0,0x0,0x0
.long 0x2d642ed7,0x3388b33b,0x3388b33b,0xad64aed7,0x0,0x0,0x0,0x0
.long 0x3072b072,0x3072b072,0xb2a732a7,0xb2a732a7,0x0,0x0,0x0,0x0
.long 0xb3fe315f,0xa24831ed,0x2248b1ed,0xb3fe315f,0x0,0x0,0x0,0x0
.long 0x3113b22f,0xb113322f,0x322f3113,0xb22fb113,0x0,0x0,0x0,0x0
.long 0x2bc632dd,0xb3c3b01d,0xb3c3b01d,0xabc6b2dd,0x0,0x0,0x0,0x0
.long 0x0,0x0,0x0,0x0,0x80008000,0x80008000,0x34003400,0x34003400
.long 0x0,0x0,0x0,0x0,0xb3eab0c4,0xa8b2b26d,0x28b2326d,0xb3eab0c4
.long 0x0,0x0,0x0,0x0,0xaca5b3a8,0x2ca533a8,0xb3a82ca5,0x33a8aca5
.long 0x0,0x0,0x0,0x0,0x333bb388,0xaed7ad64,0xaed7ad64,0xb33b3388
.long 0x0,0x0,0x0,0x0,0x3072b072,0x3072b072,0x32a7b2a7,0x32a7b2a7
.long 0x0,0x0,0x0,0x0,0xb1ed2248,0xb15f33fe,0x315fb3fe,0xb1ed2248
.long 0x0,0x0,0x0,0x0,0xb22f3113,0x322fb113,0xb113b22f,0x3113322f
.long 0x0,0x0,0x0,0x0,0x301d33c3,0xb2ddabc6,0xb2ddabc6,0xb01db3c3
.long 0x0,0x0,0x0,0x0,0x80008000,0x80008000,0x34003400,0x34003400
.long 0x0,0x0,0x0,0x0,0x33ea30c4,0x28b2326d,0xa8b2b26d,0x33ea30c4
.long 0x0,0x0,0x0,0x0,0xaca5b3a8,0x2ca533a8,0xb3a82ca5,0x33a8aca5
.long 0x0,0x0,0x0,0x0,0xb33b3388,0x2ed72d64,0x2ed72d64,0x333bb388
.long 0x0,0x0,0x0,0x0,0x3072b072,0x3072b072,0x32a7b2a7,0x32a7b2a7
.long 0x0,0x0,0x0,0x0,0x31eda248,0x315fb3fe,0xb15f33fe,0x31eda248
.long 0x0,0x0,0x0,0x0,0xb22f3113,0x322fb113,0xb113b22f,0x3113322f
.long 0x0,0x0,0x0,0x0,0xb01db3c3,0x32dd2bc6,0x32dd2bc6,0x301d33c3
.long 0x8a000,0x0,0x0,0x0,0x8c800,0x0,0x0,0x0
.long 0x8f000,0x0,0x0,0x0,0x91800,0x0,0x0,0x0
.long 0x94000,0x0,0x0,0x0,0x96800,0x0,0x0,0x0
.long 0x99000,0x0,0x0,0x0,0x9b800,0x0,0x0,0x0
.long 0x9e000,0x0,0x0,0x0,0xa0800,0x0,0x0,0x0
.long 0xa3000,0x0,0x0,0x0,0xa5800,0x0,0x0,0x0
.long 0xa8000,0x0,0x0,0x0,0xaa800,0x0,0x0,0x0
.long 0xad000,0x0,0x0,0x0,0xaf800,0x0,0x0,0x0
.long 0x8b400,0x0,0x0,0x0,0x8dc00,0x0,0x0,0x0
.long 0x90400,0x0,0x0,0x0,0x92c00,0x0,0x0,0x0
.long 0x95400,0x0,0x0,0x0,0x97c00,0x0,0x0,0x0
.long 0x9a400,0x0,0x0,0x0,0x9cc00,0x0,0x0,0x0
.long 0x9f400,0x0,0x0,0x0,0xa1c00,0x0,0x0,0x0
.long 0xa4400,0x0,0x0,0x0,0xa6c00,0x0,0x0,0x0
.long 0xa9400,0x0,0x0,0x0,0xabc00,0x0,0x0,0x0
.long 0xae400,0x0,0x0,0x0,0xb0c00,0x0,0x0,0x0
.long 0xaf810,0x0,0x0,0x0,0xad010,0x0,0x0,0x0
.long 0xaa810,0x0,0x0,0x0,0xa8010,0x0,0x0,0x0
.long 0xa5810,0x0,0x0,0x0,0xa3010,0x0,0x0,0x0
.long 0xa0810,0x0,0x0,0x0,0x9e010,0x0,0x0,0x0
.long 0x9b810,0x0,0x0,0x0,0x99010,0x0,0x0,0x0
.long 0x96810,0x0,0x0,0x0,0x94010,0x0,0x0,0x0
.long 0x91810,0x0,0x0,0x0,0x8f010,0x0,0x0,0x0
.long 0x8c810,0x0,0x0,0x0,0x8a010,0x0,0x0,0x0
.long 0xb0c10,0x0,0x0,0x0,0xae410,0x0,0x0,0x0
.long 0xabc10,0x0,0x0,0x0,0xa9410,0x0,0x0,0x0
.long 0xa6c10,0x0,0x0,0x0,0xa4410,0x0,0x0,0x0
.long 0xa1c10,0x0,0x0,0x0,0x9f410,0x0,0x0,0x0
.long 0x9cc10,0x0,0x0,0x0,0x9a410,0x0,0x0,0x0
.long 0x97c10,0x0,0x0,0x0,0x95410,0x0,0x0,0x0
.long 0x92c10,0x0,0x0,0x0,0x90410,0x0,0x0,0x0
.long 0x8dc10,0x0,0x0,0x0,0x8b410,0x0,0x0,0x0
.long 0x3c003c00,0x3c003c00,0x0,0x0,0x3bfc3c00,0x3be63bf4,0x2bd92248,0x31152f0e
.long 0x3bf13bff,0x3b993bce,0x2fd62648,0x35053303,0x3bdd3bff,0x3b1a3b91,0x31db28b6,0x375e3534
.long 0x3bc33bfe,0x3a6d3b3b,0x33c62a48,0x38c436d7,0x3ba03bfc,0x39963ad0,0x34d52bd9,0x39ba3832
.long 0x3b773bfa,0x389b3a4f,0x35c22cb5,0x3a8a38ec,0x3b463bf8,0x370539ba,0x36aa2d7e,0x3b303996
.long 0x3b0e3bf6,0x34a53913,0x378b2e46,0x3ba83a2f,0x3ad03bf4,0x304e385d,0x38322f0e,0x3bed3ab5
.long 0x3a8a3bf1,0xa6483732,0x389b2fd6,0x3bff3b25,0x3a3f3bed,0xb1db3593,0x3900304e,0x3bdd3b80
.long 0x39ed3bea,0xb56433c6,0x395f30b2,0x3b883bc3,0x39963be6,0xb7b7304e,0x39ba3115,0x3b023bed
.long 0x393a3be2,0xb8ec2648,0x3a0f3179,0x3a4f3bff,0x38d83bdd,0xb9dcad7e,0x3a5e31db,0x39723bf8
.long 0x3c003c00,0x3c003c00,0x0,0x0,0x3bbc3bd4,0x3b803ba0,0x341432a1,0x359334d5
.long 0x3af63b50,0x3a0f3a8a,0x37e3367c,0x393a389b,0x39ba3a7c,0x37b738d8,0x399638b0,0x3b023a5e
.long 0x381d395f,0x30b23564,0x3add39ed,0x3bea3b88,0x34753807,0xb2a128b6,0x3baf3ae9,0x3bd43bff
.long 0x26483505,0xb848b444,0x3bff3b99,0x3ac23bb6,0xb3652f0e,0xba5eb85d,0x3bc93bf4,0x38d83ab5
.long 0xb78bae46,0xbba8ba2f,0x3b0e3bf6,0x34a53913,0xb972b4d5,0xbbfcbb6e,0x39dc3ba0,0xabd935f1
.long 0xbac2b7e3,0xbb50bbfa,0x38483af6,0xb67c2cb5,0xbba0b94d,0xb9babbc9,0x34d539fe,0xb996b365
.long 0xbbfeba6d,0xb6d7badd,0x2a4838c4,0xbb3bb81d,0xbbd4bb46,0xad7eb94d,0xb2a136aa,0xbbf8b9fe
.long 0xbb25bbce,0x3444b67c,0xb7323303,0xbbb6bb50,0xb9febc00,0x38b0af0e,0xb94d2248,0xba7cbbf4
.long 0x3c003c00,0x3c003c00,0x0,0x0,0x3bf83bff,0x3bdd3bed,0x2d7e28b6,0x31db304e
.long 0x3be23bfa,0x3b773bb6,0x31792cb5,0x35c23444,0x3bbc3bf4,0x3ad03b5a,0x34142f0e,0x3832364e
.long 0x3b883bea,0x39ed3add,0x356430b2,0x395f381d,0x3b463bdd,0x38d83a3f,0x36aa31db,0x3a5e3900
.long 0x3af63bce,0x37323984,0x37e33303,0x3b2539cb,0x3a993bbc,0x347538b0,0x38873414,0x3baf3a7c
.long 0x3a2f3ba8,0x2e46378b,0x391334a5,0x3bf63b0e,0x39ba3b91,0xad7e3593,0x39963534,0x3bf83b80
.long 0x393a3b77,0xb4443303,0x3a0f35c2,0x3bb63bce,0x38b03b5a,0xb7052d7e,0x3a7c364e,0x3b303bf8
.long 0x381d3b3b,0xb8c4aa48,0x3add36d7,0x3a6d3bfe,0x37053b1a,0xb9dcb1db,0x3b30375e,0x39723bdd
.long 0x35c23af6,0xbac2b505,0x3b7737e3,0x38483b99,0x34753ad0,0xbb6eb705,0x3baf3832,0x35f13b30
.long 0x3c003c00,0x3c003c00,0x0,0x0,0x3baf3bc9,0x3b6e3b91,0x34753365,0x35f13534
.long 0x3ac23b25,0x39cb3a4f,0x38483732,0x398438ec,0x394d3a1f,0x36aa385d,0x39fe3927,0x3b463ab5
.long 0x36d738c4,0x2a4833c6,0x3b3b3a6d,0x3bfe3bc3,0x3115364e,0xb534ad7e,0x3be63b5a,0x3b913bf8
.long 0xafd63179,0xb93ab67c,0x3bf13be2,0x3a0f3b50,0xb64eabd9,0xbb1ab972,0x3b5a3bfc,0x375e39dc
.long 0xb913b4a5,0xbbf6bb0e,0x3a2f3ba8,0x2e46378b,0xba99b807,0xbbafbbe6,0x38873ae9,0xb4753115
.long 0xbb99b984,0xba4fbbe2,0x350539cb,0xb8ecb179,0xbbffbab5,0xb807bb02,0x28b6385d,0xbae9b7b7
.long 0xbbc3bb88,0xb0b2b95f,0xb3c63564,0xbbeab9ed,0xbae9bbf4,0x3365b64e,0xb8072f0e,0xbbc9bb5a
.long 0xb984bbf1,0x389bacb5,0xb9cbafd6,0xba8abbfa,0xb75ebb80,0x3ab53414,0xbb1ab593,0xb85dbbbc
.long 0x34003400,0x34003400,0x0,0x0,0x0,0x0,0x0,0x0
.long 0x307233d9,0xb2a7aa3e,0x32a72a3e,0x307233d9,0x0,0x0,0x0,0x0
.long 0xae1f3364,0x2e1fb364,0x33642e1f,0xb364ae1f,0x0,0x0,0x0,0x0
.long 0xb3d932a7,0x2a3e3072,0x2a3e3072,0x33d9b2a7,0x0,0x0,0x0,0x0
.long 0xb1a831a8,0xb1a831a8,0xb1a831a8,0xb1a831a8,0x0,0x0,0x0,0x0
.long 0x2a3e3072,0x33d9b2a7,0xb3d932a7,0x2a3e3072,0x0,0x0,0x0,0x0
.long 0x33642e1f,0xb364ae1f,0xae1f3364,0x2e1fb364,0x0,0x0,0x0,0x0
.long 0x32a72a3e,0x307233d9,0x307233d9,0xb2a7aa3e,0x0,0x0,0x0,0x0
.long 0x34003400,0x34003400,0x0,0x0,0x0,0x0,0x0,0x0
.long 0xb072b3d9,0x32a72a3e,0xb2a7aa3e,0xb072b3d9,0x0,0x0,0x0,0x0
.long 0xae1f3364,0x2e1fb364,0x33642e1f,0xb364ae1f,0x0,0x0,0x0,0x0
.long 0x33d9b2a7,0xaa3eb072,0xaa3eb072,0xb3d932a7,0x0,0x0,0x0,0x0
.long 0xb1a831a8,0xb1a831a8,0xb1a831a8,0xb1a831a8,0x0,0x0,0x0,0x0
.long 0xaa3eb072,0xb3d932a7,0x33d9b2a7,0xaa3eb072,0x0,0x0,0x0,0x0
.long 0x33642e1f,0xb364ae1f,0xae1f3364,0x2e1fb364,0x0,0x0,0x0,0x0
.long 0xb2a7aa3e,0xb072b3d9,0xb072b3d9,0x32a72a3e,0x0,0x0,0x0,0x0
.long 0x0,0x0,0x0,0x0,0x34003400,0x34003400,0x0,0x0
.long 0x0,0x0,0x0,0x0,0x2a3e32a7,0xb3d9b072,0x33d93072,0x2a3e32a7
.long 0x0,0x0,0x0,0x0,0xb3642e1f,0x3364ae1f,0x2e1f3364,0xae1fb364
.long 0x0,0x0,0x0,0x0,0xb072aa3e,0xb2a733d9,0xb2a733d9,0x30722a3e
.long 0x0,0x0,0x0,0x0,0x31a8b1a8,0x31a8b1a8,0xb1a831a8,0xb1a831a8
.long 0x0,0x0,0x0,0x0,0x32a7b3d9,0xb072aa3e,0x30722a3e,0x32a7b3d9
.long 0x0,0x0,0x0,0x0,0xae1fb364,0x2e1f3364,0x3364ae1f,0xb3642e1f
.long 0x0,0x0,0x0,0x0,0xb3d9b072,0xaa3eb2a7,0xaa3eb2a7,0x33d93072
.long 0x0,0x0,0x0,0x0,0x34003400,0x34003400,0x0,0x0
.long 0x0,0x0,0x0,0x0,0xaa3eb2a7,0x33d93072,0xb3d9b072,0xaa3eb2a7
.long 0x0,0x0,0x0,0x0,0xb3642e1f,0x3364ae1f,0x2e1f3364,0xae1fb364
.long 0x0,0x0,0x0,0x0,0x30722a3e,0x32a7b3d9,0x32a7b3d9,0xb072aa3e
.long 0x0,0x0,0x0,0x0,0x31a8b1a8,0x31a8b1a8,0xb1a831a8,0xb1a831a8
.long 0x0,0x0,0x0,0x0,0xb2a733d9,0x30722a3e,0xb072aa3e,0xb2a733d9
.long 0x0,0x0,0x0,0x0,0xae1fb364,0x2e1f3364,0x3364ae1f,0xb3642e1f
.long 0x0,0x0,0x0,0x0,0x33d93072,0x2a3e32a7,0x2a3e32a7,0xb3d9b072
.long 0x80008000,0x80008000,0x34003400,0x34003400,0x0,0x0,0x0,0x0
.long 0xb2a7aa3e,0xb072b3d9,0x307233d9,0xb2a7aa3e,0x0,0x0,0x0,0x0
.long 0xb364ae1f,0x33642e1f,0xae1f3364,0x2e1fb364,0x0,0x0,0x0,0x0
.long 0xaa3eb072,0xb3d932a7,0xb3d932a7,0x2a3e3072,0x0,0x0,0x0,0x0
.long 0x31a8b1a8,0x31a8b1a8,0xb1a831a8,0xb1a831a8,0x0,0x0,0x0,0x0
.long 0x33d9b2a7,0xaa3eb072,0x2a3e3072,0x33d9b2a7,0x0,0x0,0x0,0x0
.long 0x2e1fb364,0xae1f3364,0x33642e1f,0xb364ae1f,0x0,0x0,0x0,0x0
.long 0xb072b3d9,0x32a72a3e,0x32a72a3e,0x307233d9,0x0,0x0,0x0,0x0
.long 0x80008000,0x80008000,0x34003400,0x34003400,0x0,0x0,0x0,0x0
.long 0x32a72a3e,0x307233d9,0xb072b3d9,0x32a72a3e,0x0,0x0,0x0,0x0
.long 0xb364ae1f,0x33642e1f,0xae1f3364,0x2e1fb364,0x0,0x0,0x0,0x0
.long 0x2a3e3072,0x33d9b2a7,0x33d9b2a7,0xaa3eb072,0x0,0x0,0x0,0x0
.long 0x31a8b1a8,0x31a8b1a8,0xb1a831a8,0xb1a831a8,0x0,0x0,0x0,0x0
.long 0xb3d932a7,0x2a3e3072,0xaa3eb072,0xb3d932a7,0x0,0x0,0x0,0x0
.long 0x2e1fb364,0xae1f3364,0x33642e1f,0xb364ae1f,0x0,0x0,0x0,0x0
.long 0x307233d9,0xb2a7aa3e,0xb2a7aa3e,0xb072b3d9,0x0,0x0,0x0,0x0
.long 0x0,0x0,0x0,0x0,0x80008000,0x80008000,0x34003400,0x34003400
.long 0x0,0x0,0x0,0x0,0xb3d9b072,0xaa3eb2a7,0x2a3e32a7,0xb3d9b072
.long 0x0,0x0,0x0,0x0,0xae1fb364,0x2e1f3364,0xb3642e1f,0x3364ae1f
.long 0x0,0x0,0x0,0x0,0x32a7b3d9,0xb072aa3e,0xb072aa3e,0xb2a733d9
.long 0x0,0x0,0x0,0x0,0x31a8b1a8,0x31a8b1a8,0x31a8b1a8,0x31a8b1a8
.long 0x0,0x0,0x0,0x0,0xb072aa3e,0xb2a733d9,0x32a7b3d9,0xb072aa3e
.long 0x0,0x0,0x0,0x0,0xb3642e1f,0x3364ae1f,0xae1fb364,0x2e1f3364
.long 0x0,0x0,0x0,0x0,0x2a3e32a7,0xb3d9b072,0xb3d9b072,0xaa3eb2a7
.long 0x0,0x0,0x0,0x0,0x80008000,0x80008000,0x34003400,0x34003400
.long 0x0,0x0,0x0,0x0,0x33d93072,0x2a3e32a7,0xaa3eb2a7,0x33d93072
.long 0x0,0x0,0x0,0x0,0xae1fb364,0x2e1f3364,0xb3642e1f,0x3364ae1f
.long 0x0,0x0,0x0,0x0,0xb2a733d9,0x30722a3e,0x30722a3e,0x32a7b3d9
.long 0x0,0x0,0x0,0x0,0x31a8b1a8,0x31a8b1a8,0x31a8b1a8,0x31a8b1a8
.long 0x0,0x0,0x0,0x0,0x30722a3e,0x32a7b3d9,0xb2a733d9,0x30722a3e
.long 0x0,0x0,0x0,0x0,0xb3642e1f,0x3364ae1f,0xae1fb364,0x2e1f3364
.long 0x0,0x0,0x0,0x0,0xaa3eb2a7,0x33d93072,0x33d93072,0x2a3e32a7
.long 0xb2000,0x0,0x0,0x0,0xb4800,0x0,0x0,0x0
.long 0xb7000,0x0,0x0,0x0,0xb9800,0x0,0x0,0x0
.long 0xbc000,0x0,0x0,0x0,0xbe800,0x0,0x0,0x0
.long 0xc1000,0x0,0x0,0x0,0xc3800,0x0,0x0,0x0
.long 0xc6000,0x0,0x0,0x0,0xc8800,0x0,0x0,0x0
.long 0xcb000,0x0,0x0,0x0,0xcd800,0x0,0x0,0x0
.long 0xd0000,0x0,0x0,0x0,0xd2800,0x0,0x0,0x0
.long 0xd5000,0x0,0x0,0x0,0xd7800,0x0,0x0,0x0
.long 0xb3400,0x0,0x0,0x0,0xb5c00,0x0,0x0,0x0
.long 0xb8400,0x0,0x0,0x0,0xbac00,0x0,0x0,0x0
.long 0xbd400,0x0,0x0,0x0,0xbfc00,0x0,0x0,0x0
.long 0xc2400,0x0,0x0,0x0,0xc4c00,0x0,0x0,0x0
.long 0xc7400,0x0,0x0,0x0,0xc9c00,0x0,0x0,0x0
.long 0xcc400,0x0,0x0,0x0,0xcec00,0x0,0x0,0x0
.long 0xd1400,0x0,0x0,0x0,0xd3c00,0x0,0x0,0x0
.long 0xd6400,0x0,0x0,0x0,0xd8c00,0x0,0x0,0x0
.long 0xd7810,0x0,0x0,0x0,0xd5010,0x0,0x0,0x0
.long 0xd2810,0x0,0x0,0x0,0xd0010,0x0,0x0,0x0
.long 0xcd810,0x0,0x0,0x0,0xcb010,0x0,0x0,0x0
.long 0xc8810,0x0,0x0,0x0,0xc6010,0x0,0x0,0x0
.long 0xc3810,0x0,0x0,0x0,0xc1010,0x0,0x0,0x0
.long 0xbe810,0x0,0x0,0x0,0xbc010,0x0,0x0,0x0
.long 0xb9810,0x0,0x0,0x0,0xb7010,0x0,0x0,0x0
.long 0xb4810,0x0,0x0,0x0,0xb2010,0x0,0x0,0x0
.long 0xd8c10,0x0,0x0,0x0,0xd6410,0x0,0x0,0x0
.long 0xd3c10,0x0,0x0,0x0,0xd1410,0x0,0x0,0x0
.long 0xcec10,0x0,0x0,0x0,0xcc410,0x0,0x0,0x0
.long 0xc9c10,0x0,0x0,0x0,0xc7410,0x0,0x0,0x0
.long 0xc4c10,0x0,0x0,0x0,0xc2410,0x0,0x0,0x0
.long 0xbfc10,0x0,0x0,0x0,0xbd410,0x0,0x0,0x0
.long 0xbac10,0x0,0x0,0x0,0xb8410,0x0,0x0,0x0
.long 0xb5c10,0x0,0x0,0x0,0xb3410,0x0,0x0,0x0
.long 0x3c003c00,0x3c003c00,0x0,0x0,0x3bfc3c00,0x3be53bf3,0x2c1f23db,0x312e2f40
.long 0x3bef3bff,0x3b953bcb,0x301d27da,0x351d3334,0x3bda3bfe,0x3b113b8a,0x322629e3,0x37803558
.long 0x3bbc3bfc,0x3a5e3b30,0x34142bd9,0x38d83705,0x3b973bfa,0x39803abf,0x35112ce7,0x39d0384d
.long 0x3b693bf7,0x387c3a37,0x36082de2,0x3aa03909,0x3b333bf4,0x36b5399b,0x36f92edc,0x3b4339b5
.long 0x3af63bf1,0x344438ec,0x37e32fd6,0x3bb63a4f,0x3ab13bed,0x2edc382d,0x38623067,0x3bf43ad3
.long 0x3a653be8,0xab1136c1,0x38ce30e4,0x3bfd3b41,0x3a133be3,0xb2ea3511,0x39353160,0x3bd03b97
.long 0x39ba3bdd,0xb5f132a1,0x399631db,0x3b6e3bd4,0x395b3bd7,0xb8222e14,0x39f23257,0x3ad93bf7
.long 0x38f63bd1,0xb930a4b6,0x3a4732d2,0x3a173c00,0x388c3bca,0xba1bb036,0x3a95334c,0x392b3bee
.long 0x3c003c00,0x3c003c00,0x0,0x0,0x3bbb3bd2,0x3b7d3b9e,0x342032b9,0x359f34e1
.long 0x3af03b4b,0x3a073a83,0x37f93693,0x394338a6,0x39ad3a71,0x379638c9,0x39a438bf,0x3b0b3a69
.long 0x3807394d,0x304e3534,0x3ae939fe,0x3bed3b91,0x343837d8,0xb31b257f,0x3bb73af9,0x3bcd3c00
.long 0x1e4834bd,0xb867b48d,0x3c003ba4,0x3aae3bab,0xb4082db0,0xba78b881,0x3bbe3bf8,0x38b53a9c
.long 0xb7e3afd6,0xbbb6ba4f,0x3af63bf1,0x344438ec,0xb99bb540,0xbbf8bb82,0x39b53b8f,0xadb03587
.long 0xbae3b828,0xbb36bbfe,0x38123ad6,0xb6ee297f,0xbbb4b980,0xb989bbb7,0x345139d0,0xb9c7b438
.long 0xbc00ba99,0xb64ebab5,0x22483887,0xbb5ab85d,0xbbc1bb67,0xa9e3b90e,0xb3df3614,0xbbfeba33
.long 0xbafcbbe0,0x34edb5da,0xb7cd31aa,0xbb9dbb72,0xb9bebbff,0x38fbac1f,0xb992a852,0xba43bbfc
.long 0x3c003c00,0x3c003c00,0x0,0x0,0x3bf93bff,0x3bdf3bee,0x2d4c2852,0x31c33036
.long 0x3be43bfb,0x3b7b3bb9,0x31472c51,0x35ab342c,0x3bc13bf6,0x3ad93b62,0x33df2e78,0x3822362b
.long 0x3b913bed,0x39fe3ae9,0x3534304e,0x394d3807,0x3b533be3,0x38f13a52,0x36703160,0x3a4b38e7
.long 0x3b083bd6,0x3775399f,0x37a1326f,0x3b1439b1,0x3ab13bc7,0x34c938d3,0x3862337d,0x3ba23a62
.long 0x3a4f3bb6,0x2fd637e3,0x38ec3444,0x3bf13af6,0x39e13ba2,0xab7535fd,0x396d34c9,0x3bfd3b6b
.long 0x39693b8c,0xb39633f7,0x39e5354c,0x3bc63bc0,0x38e73b74,0xb6872fa4,0x3a5235ce,0x3b4e3bf1
.long 0x385d3b5a,0xb887a248,0x3ab5364e,0x3a993c00,0x37963b3e,0xb9a4b099,0x3b0b36cc,0x39ad3beb
.long 0x36653b20,0xba92b45d,0x3b553748,0x38913bb2,0x35293aff,0xbb49b659,0x3b9337c2,0x369e3b58
.long 0x3c003c00,0x3c003c00,0x0,0x0,0x3bb13bca,0x3b703b93,0x3469334c,0x35e53529
.long 0x3ac93b2b,0x39d43a56,0x383d371b,0x397b38e2,0x395b3a2b,0x36cc386d,0x39f23918,0x3b3e3aaa
.long 0x370538d8,0x2bd93414,0x3b303a5e,0x3bfc3bbc,0x31913687,0xb4f9ac83,0x3be13b4e,0x3b9b3bfb
.long 0xaeaa320d,0xb91db637,0x3bf53bdb,0x3a273b5f,0xb5fda91b,0xbb05b951,0x3b6b3bfe,0x37ac39fa
.long 0xb8ecb444,0xbbf1baf6,0x3a4f3bb6,0x2fd637e3,0xba78b7ac,0xbbbebbdc,0x38b53b05,0xb40831f4
.long 0xbb84b956,0xba74bbec,0x357c39f6,0xb8bab080,0xbbfbba8e,0xb842bb22,0x2c833896,0xbac6b73d
.long 0xbbd4bb6e,0xb1dbb996,0xb2a135f1,0xbbddb9ba,0xbb11bbe9,0x3226b6e3,0xb78030cb,0xbbdabb39
.long 0xb9c3bbf9,0x3852af72,0xb98dad1a,0xbabcbbf2,0xb802bb9e,0x3a7f32b9,0xbaedb4e1,0xb8abbbd2
.long 0x34003400,0x34003400,0x0,0x0,0x0,0x0,0x0,0x0
.long 0x301d33c3,0xb2ddabc6,0x32dd2bc6,0x301d33c3,0x0,0x0,0x0,0x0
.long 0xaf8b330e,0x2f8bb30e,0x330e2f8b,0xb30eaf8b,0x0,0x0,0x0,0x0
.long 0xb3fe31ed,0x2248315f,0x2248315f,0x33feb1ed,0x0,0x0,0x0,0x0
.long 0xb0723072,0xb0723072,0xb2a732a7,0xb2a732a7,0x0,0x0,0x0,0x0
.long 0x2ed72d64,0x333bb388,0xb33b3388,0x2ed72d64,0x0,0x0,0x0,0x0
.long 0x33f62646,0xb3f6a646,0xa64633f6,0x2646b3f6,0x0,0x0,0x0,0x0
.long 0x30c4a8b2,0x326d33ea,0x326d33ea,0xb0c428b2,0x0,0x0,0x0,0x0
.long 0x34003400,0x34003400,0x0,0x0,0x0,0x0,0x0,0x0
.long 0xb01db3c3,0x32dd2bc6,0xb2ddabc6,0xb01db3c3,0x0,0x0,0x0,0x0
.long 0xaf8b330e,0x2f8bb30e,0x330e2f8b,0xb30eaf8b,0x0,0x0,0x0,0x0
.long 0x33feb1ed,0xa248b15f,0xa248b15f,0xb3fe31ed,0x0,0x0,0x0,0x0
.long 0xb0723072,0xb0723072,0xb2a732a7,0xb2a732a7,0x0,0x0,0x0,0x0
.long 0xaed7ad64,0xb33b3388,0x333bb388,0xaed7ad64,0x0,0x0,0x0,0x0
.long 0x33f62646,0xb3f6a646,0xa64633f6,0x2646b3f6,0x0,0x0,0x0,0x0
.long 0xb0c428b2,0xb26db3ea,0xb26db3ea,0x30c4a8b2,0x0,0x0,0x0,0x0
.long 0x0,0x0,0x0,0x0,0x34003400,0x34003400,0x0,0x0
.long 0x0,0x0,0x0,0x0,0x2bc632dd,0xb3c3b01d,0x33c3301d,0x2bc632dd
.long 0x0,0x0,0x0,0x0,0xb30e2f8b,0x330eaf8b,0x2f8b330e,0xaf8bb30e
.long 0x0,0x0,0x0,0x0,0xb15fa248,0xb1ed33fe,0xb1ed33fe,0x315f2248
.long 0x0,0x0,0x0,0x0,0x3072b072,0x3072b072,0xb2a732a7,0xb2a732a7
.long 0x0,0x0,0x0,0x0,0x3388b33b,0xad64aed7,0x2d642ed7,0x3388b33b
.long 0x0,0x0,0x0,0x0,0xa646b3f6,0x264633f6,0x33f6a646,0xb3f62646
.long 0x0,0x0,0x0,0x0,0xb3eab26d,0x28b2b0c4,0x28b2b0c4,0x33ea326d
.long 0x0,0x0,0x0,0x0,0x34003400,0x34003400,0x0,0x0
.long 0x0,0x0,0x0,0x0,0xabc6b2dd,0x33c3301d,0xb3c3b01d,0xabc6b2dd
.long 0x0,0x0,0x0,0x0,0xb30e2f8b,0x330eaf8b,0x2f8b330e,0xaf8bb30e
.long 0x0,0x0,0x0,0x0,0x315f2248,0x31edb3fe,0x31edb3fe,0xb15fa248
.long 0x0,0x0,0x0,0x0,0x3072b072,0x3072b072,0xb2a732a7,0xb2a732a7
.long 0x0,0x0,0x0,0x0,0xb388333b,0x2d642ed7,0xad64aed7,0xb388333b
.long 0x0,0x0,0x0,0x0,0xa646b3f6,0x264633f6,0x33f6a646,0xb3f62646
.long 0x0,0x0,0x0,0x0,0x33ea326d,0xa8b230c4,0xa8b230c4,0xb3eab26d
.long 0x80008000,0x80008000,0x34003400,0x34003400,0x0,0x0,0x0,0x0
.long 0xb2ddabc6,0xb01db3c3,0x301d33c3,0xb2ddabc6,0x0,0x0,0x0,0x0
.long 0xb30eaf8b,0x330e2f8b,0xaf8b330e,0x2f8bb30e,0x0,0x0,0x0,0x0
.long 0xa248b15f,0xb3fe31ed,0xb3fe31ed,0x2248315f,0x0,0x0,0x0,0x0
.long 0x32a7b2a7,0x32a7b2a7,0xb0723072,0xb0723072,0x0,0x0,0x0,0x0
.long 0x333bb388,0xaed7ad64,0x2ed72d64,0x333bb388,0x0,0x0,0x0,0x0
.long 0x2646b3f6,0xa64633f6,0x33f62646,0xb3f6a646,0x0,0x0,0x0,0x0
.long 0xb26db3ea,0x30c4a8b2,0x30c4a8b2,0x326d33ea,0x0,0x0,0x0,0x0
.long 0x80008000,0x80008000,0x34003400,0x34003400,0x0,0x0,0x0,0x0
.long 0x32dd2bc6,0x301d33c3,0xb01db3c3,0x32dd2bc6,0x0,0x0,0x0,0x0
.long 0xb30eaf8b,0x330e2f8b,0xaf8b330e,0x2f8bb30e,0x0,0x0,0x0,0x0
.long 0x2248315f,0x33feb1ed,0x33feb1ed,0xa248b15f,0x0,0x0,0x0,0x0
.long 0x32a7b2a7,0x32a7b2a7,0xb0723072,0xb0723072,0x0,0x0,0x0,0x0
.long 0xb33b3388,0x2ed72d64,0xaed7ad64,0xb33b3388,0x0,0x0,0x0,0x0
.long 0x2646b3f6,0xa64633f6,0x33f62646,0xb3f6a646,0x0,0x0,0x0,0x0
.long 0x326d33ea,0xb0c428b2,0xb0c428b2,0xb26db3ea,0x0,0x0,0x0,0x0
.long 0x0,0x0,0x0,0x0,0x80008000,0x80008000,0x34003400,0x34003400
.long 0x0,0x0,0x0,0x0,0xb3c3b01d,0xabc6b2dd,0x2bc632dd,0xb3c3b01d
.long 0x0,0x0,0x0,0x0,0xaf8bb30e,0x2f8b330e,0xb30e2f8b,0x330eaf8b
.long 0x0,0x0,0x0,0x0,0x31edb3fe,0xb15fa248,0xb15fa248,0xb1ed33fe
.long 0x0,0x0,0x0,0x0,0x32a7b2a7,0x32a7b2a7,0x3072b072,0x3072b072
.long 0x0,0x0,0x0,0x0,0xad64aed7,0xb388333b,0x3388b33b,0xad64aed7
.long 0x0,0x0,0x0,0x0,0xb3f62646,0x33f6a646,0xa646b3f6,0x264633f6
.long 0x0,0x0,0x0,0x0,0xa8b230c4,0xb3eab26d,0xb3eab26d,0x28b2b0c4
.long 0x0,0x0,0x0,0x0,0x80008000,0x80008000,0x34003400,0x34003400
.long 0x0,0x0,0x0,0x0,0x33c3301d,0x2bc632dd,0xabc6b2dd,0x33c3301d
.long 0x0,0x0,0x0,0x0,0xaf8bb30e,0x2f8b330e,0xb30e2f8b,0x330eaf8b
.long 0x0,0x0,0x0,0x0,0xb1ed33fe,0x315f2248,0x315f2248,0x31edb3fe
.long 0x0,0x0,0x0,0x0,0x32a7b2a7,0x32a7b2a7,0x3072b072,0x3072b072
.long 0x0,0x0,0x0,0x0,0x2d642ed7,0x3388b33b,0xb388333b,0x2d642ed7
.long 0x0,0x0,0x0,0x0,0xb3f62646,0x33f6a646,0xa646b3f6,0x264633f6
.long 0x0,0x0,0x0,0x0,0x28b2b0c4,0x33ea326d,0x33ea326d,0xa8b230c4
.long 0xda000,0x0,0x0,0x0,0xdc800,0x0,0x0,0x0
.long 0xdf000,0x0,0x0,0x0,0xe1800,0x0,0x0,0x0
.long 0xe4000,0x0,0x0,0x0,0xe6800,0x0,0x0,0x0
.long 0xe9000,0x0,0x0,0x0,0xeb800,0x0,0x0,0x0
.long 0xee000,0x0,0x0,0x0,0xf0800,0x0,0x0,0x0
.long 0xf3000,0x0,0x0,0x0,0xf5800,0x0,0x0,0x0
.long 0xf8000,0x0,0x0,0x0,0xfa800,0x0,0x0,0x0
.long 0xfd000,0x0,0x0,0x0,0xff800,0x0,0x0,0x0
.long 0xdb400,0x0,0x0,0x0,0xddc00,0x0,0x0,0x0
.long 0xe0400,0x0,0x0,0x0,0xe2c00,0x0,0x0,0x0
.long 0xe5400,0x0,0x0,0x0,0xe7c00,0x0,0x0,0x0
.long 0xea400,0x0,0x0,0x0,0xecc00,0x0,0x0,0x0
.long 0xef400,0x0,0x0,0x0,0xf1c00,0x0,0x0,0x0
.long 0xf4400,0x0,0x0,0x0,0xf6c00,0x0,0x0,0x0
.long 0xf9400,0x0,0x0,0x0,0xfbc00,0x0,0x0,0x0
.long 0xfe400,0x0,0x0,0x0,0x100c00,0x0,0x0,0x0
.long 0xff810,0x0,0x0,0x0,0xfd010,0x0,0x0,0x0
.long 0xfa810,0x0,0x0,0x0,0xf8010,0x0,0x0,0x0
.long 0xf5810,0x0,0x0,0x0,0xf3010,0x0,0x0,0x0
.long 0xf0810,0x0,0x0,0x0,0xee010,0x0,0x0,0x0
.long 0xeb810,0x0,0x0,0x0,0xe9010,0x0,0x0,0x0
.long 0xe6810,0x0,0x0,0x0,0xe4010,0x0,0x0,0x0
.long 0xe1810,0x0,0x0,0x0,0xdf010,0x0,0x0,0x0
.long 0xdc810,0x0,0x0,0x0,0xda010,0x0,0x0,0x0
.long 0x100c10,0x0,0x0,0x0,0xfe410,0x0,0x0,0x0
.long 0xfbc10,0x0,0x0,0x0,0xf9410,0x0,0x0,0x0
.long 0xf6c10,0x0,0x0,0x0,0xf4410,0x0,0x0,0x0
.long 0xf1c10,0x0,0x0,0x0,0xef410,0x0,0x0,0x0
.long 0xecc10,0x0,0x0,0x0,0xea410,0x0,0x0,0x0
.long 0xe7c10,0x0,0x0,0x0,0xe5410,0x0,0x0,0x0
.long 0xe2c10,0x0,0x0,0x0,0xe0410,0x0,0x0,0x0
.long 0xddc10,0x0,0x0,0x0,0xdb410,0x0,0x0,0x0
.long 0x3c003c00,0x3c003c00,0x0,0x0,0x3bfb3c00,0x3be43bf2,0x2c5124b6,0x31472f72
.long 0x3bed3bff,0x3b913bc9,0x304e28b6,0x35343365,0x3bd63bfd,0x3b083b84,0x326f2b11,0x37a1357c
.long 0x3bb63bfa,0x3a4f3b25,0x34442cb5,0x38ec3732,0x3b8c3bf7,0x39693aae,0x354c2de2,0x39e53867
.long 0x3b5a3bf4,0x385d3a1f,0x364e2f0e,0x3ab53927,0x3b203bef,0x3665397b,0x3748301d,0x3b5539d4
.long 0x3add3bea,0x33c638c4,0x381d30b2,0x3bc33a6d,0x3a923be4,0x2d1a37f9,0x38913147,0x3bf93af0
.long 0x3a3f3bdd,0xad7e364e,0x390031db,0x3bf83b5a,0x39e53bd6,0xb3f7348d,0x3969326f,0x3bc03bab
.long 0x39843bce,0xb67c3179,0x39cb3303,0x3b503be2,0x391d3bc6,0xb8672b11,0x3a273396,0x3aae3bfd
.long 0x38b03bbc,0xb972abd9,0x3a7c3414,0x39dc3bfc,0x383d3bb2,0xba56b1aa,0x3ac9345d,0x38e23be0
.long 0x3c003c00,0x3c003c00,0x0,0x0,0x3bb93bd1,0x3b7b3b9d,0x342c32d2,0x35ab34ed
.long 0x3ae93b46,0x39fe3a7c,0x380736aa,0x394d38b0,0x399f3a65,0x377538ba,0x39b138ce,0x3b143a74
.long 0x37e3393a,0x2fd63505,0x3af63a0f,0x3bf13b99,0x33f737a1,0xb3961e48,0x3bc03b08,0x3bc63c00
.long 0xa2483475,0xb887b4d5,0x3c003baf,0x3a993ba0,0xb45d2c51,0xba92b8a6,0x3bb23bfb,0x38913a83
.long 0xb81db0b2,0xbbc3ba6d,0x3add3bea,0x33c638c4,0xb9c3b5ab,0xbbf2bb95,0x398d3b7b,0xaf72351d
.long 0xbb02b85d,0xbb1abc00,0x37b73ab5,0xb75e2248,0xbbc6b9b1,0xb956bba4,0x3396399f,0xb9f6b4bd
.long 0xbbffbac2,0xb5c2ba8a,0xa6483848,0xbb77b89b,0xbbabbb84,0x9e48b8ce,0xb48d357c,0xbc00ba65
.long 0xbad0bbed,0x3593b534,0xb832304e,0xbb80bb91,0xb97bbbf9,0x3943a4b6,0xb9d4ad1a,0xba07bc00
.long 0x3c003c00,0x3c003c00,0x0,0x0,0x3bf93bff,0x3be03bef,0x2d1a27da,0x31aa301d
.long 0x3be63bfc,0x3b803bbc,0x31152bd9,0x35933414,0x3bc63bf7,0x3ae33b69,0x33962de2,0x38123608
.long 0x3b993bf1,0x3a0f3af6,0x35052fd6,0x393a37e3,0x3b5f3be8,0x39093a65,0x363730e4,0x3a3738ce
.long 0x3b1a3bdd,0x37b739ba,0x375e31db,0x3b023996,0x3ac93bd1,0x351d38f6,0x383d32d2,0x3b953a47
.long 0x3a6d3bc3,0x30b2381d,0x38c433c6,0x3bea3add,0x3a073bb2,0xa7da3665,0x3943345d,0x3bff3b55
.long 0x39963ba0,0xb2a13475,0x39ba34d5,0x3bd43baf,0x391d3b8c,0xb60830e4,0x3a27354c,0x3b693be8
.long 0x389b3b77,0xb8482648,0x3a8a35c2,0x3ac23bff,0x38123b5f,0xb969aeaa,0x3ae33637,0x39e53bf5
.long 0x37053b46,0xba5eb365,0x3b3036aa,0x38d83bc9,0x35da3b2b,0xbb20b5ab,0x3b72371b,0x37483b7b
.long 0x3c003c00,0x3c003c00,0x0,0x0,0x3bb23bcb,0x3b723b95,0x345d3334,0x35da351d
.long 0x3ad03b30,0x39dc3a5e,0x38323705,0x397238d8,0x39693a37,0x36ee387c,0x39e53909,0x3b363aa0
.long 0x373238ec,0x2cb53444,0x3b253a4f,0x3bfa3bb6,0x320d36c1,0xb4bdab11,0x3bdb3b41,0x3ba43bfd
.long 0xad7e32a1,0xb900b5f1,0x3bf83bd4,0x3a3f3b6e,0xb5aba4b6,0xbaf0b930,0x3b7b3c00,0x37f93a17
.long 0xb8c4b3c6,0xbbeabadd,0x3a6d3bc3,0x30b2381d,0xba56b748,0xbbcbbbd1,0x38e23b20,0xb33432d2
.long 0xbb6eb927,0xba99bbf4,0x35f13a1f,0xb887af0e,0xbbf5ba65,0xb87cbb41,0x2eaa38ce,0xbaa0b6c1
.long 0xbbe2bb50,0xb303b9cb,0xb179367c,0xbbceb984,0xbb36bbdb,0x30e4b775,0xb6ee320d,0xbbe8bb14
.long 0xb9febbff,0x3807b115,0xb94da8b6,0xbae9bbe6,0xb852bbb9,0x3a473147,0xbabcb42c,0xb8f6bbe4
.long 0x34003400,0x34003400,0x0,0x0,0x0,0x0,0x0,0x0
.long 0x2f8b33a8,0xb30eaca5,0x330e2ca5,0x2f8b33a8,0x0,0x0,0x0,0x0
.long 0xb07232a7,0x3072b2a7,0x32a73072,0xb2a7b072,0x0,0x0,0x0,0x0
.long 0xb3f63113,0xa646322f,0xa646322f,0x33f6b113,0x0,0x0,0x0,0x0
.long 0xae1f2e1f,0xae1f2e1f,0xb3643364,0xb3643364,0x0,0x0,0x0,0x0
.long 0x31132646,0x322fb3f6,0xb22f33f6,0x31132646,0x0,0x0,0x0,0x0
.long 0x33d9aa3e,0xb3d92a3e,0x2a3e33d9,0xaa3eb3d9,0x0,0x0,0x0,0x0
.long 0x2ca5af8b,0x33a8330e,0x33a8330e,0xaca52f8b,0x0,0x0,0x0,0x0
.long 0x34003400,0x34003400,0x0,0x0,0x0,0x0,0x0,0x0
.long 0xaf8bb3a8,0x330e2ca5,0xb30eaca5,0xaf8bb3a8,0x0,0x0,0x0,0x0
.long 0xb07232a7,0x3072b2a7,0x32a73072,0xb2a7b072,0x0,0x0,0x0,0x0
.long 0x33f6b113,0x2646b22f,0x2646b22f,0xb3f63113,0x0,0x0,0x0,0x0
.long 0xae1f2e1f,0xae1f2e1f,0xb3643364,0xb3643364,0x0,0x0,0x0,0x0
.long 0xb113a646,0xb22f33f6,0x322fb3f6,0xb113a646,0x0,0x0,0x0,0x0
.long 0x33d9aa3e,0xb3d92a3e,0x2a3e33d9,0xaa3eb3d9,0x0,0x0,0x0,0x0
.long 0xaca52f8b,0xb3a8b30e,0xb3a8b30e,0x2ca5af8b,0x0,0x0,0x0,0x0
.long 0x0,0x0,0x0,0x0,0x34003400,0x34003400,0x0,0x0
.long 0x0,0x0,0x0,0x0,0x2ca5330e,0xb3a8af8b,0x33a82f8b,0x2ca5330e
.long 0x0,0x0,0x0,0x0,0xb2a73072,0x32a7b072,0x307232a7,0xb072b2a7
.long 0x0,0x0,0x0,0x0,0xb22f2646,0xb11333f6,0xb11333f6,0x322fa646
.long 0x0,0x0,0x0,0x0,0x2e1fae1f,0x2e1fae1f,0xb3643364,0xb3643364
.long 0x0,0x0,0x0,0x0,0x33f6b22f,0xa646b113,0x26463113,0x33f6b22f
.long 0x0,0x0,0x0,0x0,0x2a3eb3d9,0xaa3e33d9,0x33d92a3e,0xb3d9aa3e
.long 0x0,0x0,0x0,0x0,0xb30eb3a8,0x2f8baca5,0x2f8baca5,0x330e33a8
.long 0x0,0x0,0x0,0x0,0x34003400,0x34003400,0x0,0x0
.long 0x0,0x0,0x0,0x0,0xaca5b30e,0x33a82f8b,0xb3a8af8b,0xaca5b30e
.long 0x0,0x0,0x0,0x0,0xb2a73072,0x32a7b072,0x307232a7,0xb072b2a7
.long 0x0,0x0,0x0,0x0,0x322fa646,0x3113b3f6,0x3113b3f6,0xb22f2646
.long 0x0,0x0,0x0,0x0,0x2e1fae1f,0x2e1fae1f,0xb3643364,0xb3643364
.long 0x0,0x0,0x0,0x0,0xb3f6322f,0x26463113,0xa646b113,0xb3f6322f
.long 0x0,0x0,0x0,0x0,0x2a3eb3d9,0xaa3e33d9,0x33d92a3e,0xb3d9aa3e
.long 0x0,0x0,0x0,0x0,0x330e33a8,0xaf8b2ca5,0xaf8b2ca5,0xb30eb3a8
.long 0x80008000,0x80008000,0x34003400,0x34003400,0x0,0x0,0x0,0x0
.long 0xb30eaca5,0xaf8bb3a8,0x2f8b33a8,0xb30eaca5,0x0,0x0,0x0,0x0
.long 0xb2a7b072,0x32a73072,0xb07232a7,0x3072b2a7,0x0,0x0,0x0,0x0
.long 0x2646b22f,0xb3f63113,0xb3f63113,0xa646322f,0x0,0x0,0x0,0x0
.long 0x3364b364,0x3364b364,0xae1f2e1f,0xae1f2e1f,0x0,0x0,0x0,0x0
.long 0x322fb3f6,0xb113a646,0x31132646,0x322fb3f6,0x0,0x0,0x0,0x0
.long 0xaa3eb3d9,0x2a3e33d9,0x33d9aa3e,0xb3d92a3e,0x0,0x0,0x0,0x0
.long 0xb3a8b30e,0x2ca5af8b,0x2ca5af8b,0x33a8330e,0x0,0x0,0x0,0x0
.long 0x80008000,0x80008000,0x34003400,0x34003400,0x0,0x0,0x0,0x0
.long 0x330e2ca5,0x2f8b33a8,0xaf8bb3a8,0x330e2ca5,0x0,0x0,0x0,0x0
.long 0xb2a7b072,0x32a73072,0xb07232a7,0x3072b2a7,0x0,0x0,0x0,0x0
.long 0xa646322f,0x33f6b113,0x33f6b113,0x2646b22f,0x0,0x0,0x0,0x0
.long 0x3364b364,0x3364b364,0xae1f2e1f,0xae1f2e1f,0x0,0x0,0x0,0x0
.long 0xb22f33f6,0x31132646,0xb113a646,0xb22f33f6,0x0,0x0,0x0,0x0
.long 0xaa3eb3d9,0x2a3e33d9,0x33d9aa3e,0xb3d92a3e,0x0,0x0,0x0,0x0
.long 0x33a8330e,0xaca52f8b,0xaca52f8b,0xb3a8b30e,0x0,0x0,0x0,0x0
.long 0x0,0x0,0x0,0x0,0x80008000,0x80008000,0x34003400,0x34003400
.long 0x0,0x0,0x0,0x0,0xb3a8af8b,0xaca5b30e,0x2ca5330e,0xb3a8af8b
.long 0x0,0x0,0x0,0x0,0xb072b2a7,0x307232a7,0xb2a73072,0x32a7b072
.long 0x0,0x0,0x0,0x0,0x3113b3f6,0xb22f2646,0xb22f2646,0xb11333f6
.long 0x0,0x0,0x0,0x0,0x3364b364,0x3364b364,0x2e1fae1f,0x2e1fae1f
.long 0x0,0x0,0x0,0x0,0xa646b113,0xb3f6322f,0x33f6b22f,0xa646b113
.long 0x0,0x0,0x0,0x0,0xb3d9aa3e,0x33d92a3e,0x2a3eb3d9,0xaa3e33d9
.long 0x0,0x0,0x0,0x0,0xaf8b2ca5,0xb30eb3a8,0xb30eb3a8,0x2f8baca5
.long 0x0,0x0,0x0,0x0,0x80008000,0x80008000,0x34003400,0x34003400
.long 0x0,0x0,0x0,0x0,0x33a82f8b,0x2ca5330e,0xaca5b30e,0x33a82f8b
.long 0x0,0x0,0x0,0x0,0xb072b2a7,0x307232a7,0xb2a73072,0x32a7b072
.long 0x0,0x0,0x0,0x0,0xb11333f6,0x322fa646,0x322fa646,0x3113b3f6
.long 0x0,0x0,0x0,0x0,0x3364b364,0x3364b364,0x2e1fae1f,0x2e1fae1f
.long 0x0,0x0,0x0,0x0,0x26463113,0x33f6b22f,0xb3f6322f,0x26463113
.long 0x0,0x0,0x0,0x0,0xb3d9aa3e,0x33d92a3e,0x2a3eb3d9,0xaa3e33d9
.long 0x0,0x0,0x0,0x0,0x2f8baca5,0x330e33a8,0x330e33a8,0xaf8b2ca5
.long 0x102000,0x0,0x0,0x0,0x104800,0x0,0x0,0x0
.long 0x107000,0x0,0x0,0x0,0x109800,0x0,0x0,0x0
.long 0x10c000,0x0,0x0,0x0,0x10e800,0x0,0x0,0x0
.long 0x111000,0x0,0x0,0x0,0x113800,0x0,0x0,0x0
.long 0x116000,0x0,0x0,0x0,0x118800,0x0,0x0,0x0
.long 0x11b000,0x0,0x0,0x0,0x11d800,0x0,0x0,0x0
.long 0x120000,0x0,0x0,0x0,0x122800,0x0,0x0,0x0
.long 0x125000,0x0,0x0,0x0,0x127800,0x0,0x0,0x0
.long 0x103400,0x0,0x0,0x0,0x105c00,0x0,0x0,0x0
.long 0x108400,0x0,0x0,0x0,0x10ac00,0x0,0x0,0x0
.long 0x10d400,0x0,0x0,0x0,0x10fc00,0x0,0x0,0x0
.long 0x112400,0x0,0x0,0x0,0x114c00,0x0,0x0,0x0
.long 0x117400,0x0,0x0,0x0,0x119c00,0x0,0x0,0x0
.long 0x11c400,0x0,0x0,0x0,0x11ec00,0x0,0x0,0x0
.long 0x121400,0x0,0x0,0x0,0x123c00,0x0,0x0,0x0
.long 0x126400,0x0,0x0,0x0,0x128c00,0x0,0x0,0x0
.long 0x127810,0x0,0x0,0x0,0x125010,0x0,0x0,0x0
.long 0x122810,0x0,0x0,0x0,0x120010,0x0,0x0,0x0
.long 0x11d810,0x0,0x0,0x0,0x11b010,0x0,0x0,0x0
.long 0x118810,0x0,0x0,0x0,0x116010,0x0,0x0,0x0
.long 0x113810,0x0,0x0,0x0,0x111010,0x0,0x0,0x0
.long 0x10e810,0x0,0x0,0x0,0x10c010,0x0,0x0,0x0
.long 0x109810,0x0,0x0,0x0,0x107010,0x0,0x0,0x0
.long 0x104810,0x0,0x0,0x0,0x102010,0x0,0x0,0x0
.long 0x128c10,0x0,0x0,0x0,0x126410,0x0,0x0,0x0
.long 0x123c10,0x0,0x0,0x0,0x121410,0x0,0x0,0x0
.long 0x11ec10,0x0,0x0,0x0,0x11c410,0x0,0x0,0x0
.long 0x119c10,0x0,0x0,0x0,0x117410,0x0,0x0,0x0
.long 0x114c10,0x0,0x0,0x0,0x112410,0x0,0x0,0x0
.long 0x10fc10,0x0,0x0,0x0,0x10d410,0x0,0x0,0x0
.long 0x10ac10,0x0,0x0,0x0,0x108410,0x0,0x0,0x0
.long 0x105c10,0x0,0x0,0x0,0x103410,0x0,0x0,0x0
.long 0x3c003c00,0x3c003c00,0x0,0x0,0x3bfb3c00,0x3be33bf1,0x2c83257f,0x31602fa4
.long 0x3bec3bfe,0x3b8c3bc6,0x3080297f,0x354c3396,0x3bd23bfc,0x3aff3b7d,0x32b92c1f,0x37c2359f
.long 0x3baf3bf8,0x3a3f3b1a,0x34752d7e,0x3900375e,0x3b823bf4,0x39513a9c,0x35872edc,0x39fa3881
.long 0x3b4b3bef,0x383d3a07,0x3693301d,0x3ac93943,0x3b0b3be9,0x3614395b,0x379630cb,0x3b6739f2
.long 0x3ac23be2,0x3303389b,0x38483179,0x3bce3a8a,0x3a713bda,0x2aac3796,0x38bf3226,0x3bfd3b0b
.long 0x3a173bd1,0xaf7235da,0x393032d2,0x3bf23b72,0x39b53bc7,0xb4813408,0x399b337d,0x3bad3bbe
.long 0x394d3bbc,0xb705304e,0x39fe3414,0x3b303bed,0x38dd3bb1,0xb8ab23db,0x3a5a3469,0x3a7f3c00
.long 0x38673ba4,0xb9b1aeaa,0x3aae34bd,0x399f3bf5,0x37d83b97,0xba8eb31b,0x3af93511,0x38963bcd
.long 0x3c003c00,0x3c003c00,0x0,0x0,0x3bb73bd0,0x3b793b9b,0x343832ea,0x35b634f9
.long 0x3ae33b41,0x39f63a74,0x381236c1,0x395638ba,0x39923a5a,0x375338ab,0x39be38dd,0x3b1d3a7f
.long 0x37b73927,0x2f0e34d5,0x3b023a1f,0x3bf43ba0,0x337d376a,0xb408a0b6,0x3bc73b17,0x3bbe3c00
.long 0xa7da342c,0xb8a6b51d,0x3bff3bb9,0x3a833b95,0xb4b129e3,0xbaaab8c9,0x3ba63bfe,0x386d3a69
.long 0xb848b179,0xbbceba8a,0x3ac23be2,0x3303389b,0xb9e9b614,0xbbebbba6,0x39643b67,0xb09934b1
.long 0xbb20b891,0xbafcbc00,0x37483a92,0xb7cda4b6,0xbbd5b9e1,0xb922bb8f,0x3288396d,0xba23b540
.long 0xbbfcbae9,0xb534ba5e,0xabd93807,0xbb91b8d8,0xbb93bb9e,0x2852b88c,0xb52934e1,0xbbffba95
.long 0xbaa0bbf7,0x3637b48d,0xb87c2de2,0xbb5fbbab,0xb935bbf0,0x39892711,0xba13b004,0xb9c7bbff
.long 0x3c003c00,0x3c003c00,0x0,0x0,0x3bfa3bff,0x3be13bf0,0x2ce72711,0x31913004
.long 0x3be83bfd,0x3b843bc0,0x30e42b11,0x357c33f7,0x3bca3bf9,0x3aed3b70,0x334c2d4c,0x380235e5
.long 0x3ba03bf4,0x3a1f3b02,0x34d52f0e,0x392737b7,0x3b6b3bed,0x39223a78,0x35fd3067,0x3a2338b5
.long 0x3b2b3be4,0x37f939d4,0x371b3147,0x3af0397b,0x3ae03bda,0x35703918,0x38173226,0x3b863a2b
.long 0x3a8a3bce,0x31793848,0x389b3303,0x3be23ac2,0x3a2b3bc1,0x9a4836cc,0x391833df,0x3c003b3e
.long 0x39c33bb2,0xb1aa34ed,0x398d345d,0x3be03b9d,0x39513ba2,0xb58731f4,0x39fa34c9,0x3b823bdc
.long 0x38d83b91,0xb8072bd9,0x3a5e3534,0x3ae93bfc,0x38583b7d,0xb92bac1f,0x3ab8359f,0x3a1b3bfc
.long 0x37a13b69,0xba27b20d,0x3b083608,0x391d3bdb,0x36873b53,0xbaf3b4f9,0x3b4e3670,0x37ee3b9b
.long 0x3c003c00,0x3c003c00,0x0,0x0,0x3bb43bcd,0x3b743b97,0x3451331b,0x35ce3511
.long 0x3ad63b36,0x39e53a65,0x382836ee,0x396938ce,0x39763a43,0x3710388c,0x39d838fb,0x3b2e3a95
.long 0x375e3900,0x2d7e3475,0x3b1a3a3f,0x3bf83baf,0x328836f9,0xb481a91b,0x3bd53b33,0x3bad3bfe
.long 0xac513334,0xb8e2b5ab,0x3bfb3bcb,0x3a563b7b,0xb5581a48,0xbad9b90e,0x3b8a3c00,0x38223a33
.long 0xb89bb303,0xbbe2bac2,0x3a8a3bce,0x31793848,0xba33b6e3,0xbbd7bbc4,0x390e3b39,0xb25733ae
.long 0xbb55b8f6,0xbabcbbf9,0x36653a47,0xb852ad1a,0xbbedba3b,0xb8b5bb5d,0x30673905,0xba78b642
.long 0xbbedbb30,0xb414b9fe,0xb04e3705,0xbbbcb94d,0xbb58bbca,0x2f40b802,0xb659334c,0xbbf3baed
.long 0xba37bc00,0x3775b26f,0xb9091e48,0xbb14bbd6,0xb8a0bbd0,0x3a0b2fa4,0xba87b2ea,0xb93ebbf1
.long 0x34003400,0x34003400,0x0,0x0,0x0,0x0,0x0,0x0
.long 0x2ed73388,0xb33bad64,0x333b2d64,0x2ed73388,0x0,0x0,0x0,0x0
.long 0xb113322f,0x3113b22f,0x322f3113,0xb22fb113,0x0,0x0,0x0,0x0
.long 0xb3c3301d,0xabc632dd,0xabc632dd,0x33c3b01d,0x0,0x0,0x0,0x0
.long 0xaa3e2a3e,0xaa3e2a3e,0xb3d933d9,0xb3d933d9,0x0,0x0,0x0,0x0
.long 0x326da8b2,0x30c4b3ea,0xb0c433ea,0x326da8b2,0x0,0x0,0x0,0x0
.long 0x330eaf8b,0xb30e2f8b,0x2f8b330e,0xaf8bb30e,0x0,0x0,0x0,0x0
.long 0xa248b1ed,0x33fe315f,0x33fe315f,0x224831ed,0x0,0x0,0x0,0x0
.long 0x34003400,0x34003400,0x0,0x0,0x0,0x0,0x0,0x0
.long 0xaed7b388,0x333b2d64,0xb33bad64,0xaed7b388,0x0,0x0,0x0,0x0
.long 0xb113322f,0x3113b22f,0x322f3113,0xb22fb113,0x0,0x0,0x0,0x0
.long 0x33c3b01d,0x2bc6b2dd,0x2bc6b2dd,0xb3c3301d,0x0,0x0,0x0,0x0
.long 0xaa3e2a3e,0xaa3e2a3e,0xb3d933d9,0xb3d933d9,0x0,0x0,0x0,0x0
.long 0xb26d28b2,0xb0c433ea,0x30c4b3ea,0xb26d28b2,0x0,0x0,0x0,0x0
.long 0x330eaf8b,0xb30e2f8b,0x2f8b330e,0xaf8bb30e,0x0,0x0,0x0,0x0
.long 0x224831ed,0xb3feb15f,0xb3feb15f,0xa248b1ed,0x0,0x0,0x0,0x0
.long 0x0,0x0,0x0,0x0,0x34003400,0x34003400,0x0,0x0
.long 0x0,0x0,0x0,0x0,0x2d64333b,0xb388aed7,0x33882ed7,0x2d64333b
.long 0x0,0x0,0x0,0x0,0xb22f3113,0x322fb113,0x3113322f,0xb113b22f
.long 0x0,0x0,0x0,0x0,0xb2dd2bc6,0xb01d33c3,0xb01d33c3,0x32ddabc6
.long 0x0,0x0,0x0,0x0,0x2a3eaa3e,0x2a3eaa3e,0xb3d933d9,0xb3d933d9
.long 0x0,0x0,0x0,0x0,0x33eab0c4,0x28b2b26d,0xa8b2326d,0x33eab0c4
.long 0x0,0x0,0x0,0x0,0x2f8bb30e,0xaf8b330e,0x330e2f8b,0xb30eaf8b
.long 0x0,0x0,0x0,0x0,0xb15fb3fe,0x31ed2248,0x31ed2248,0x315f33fe
.long 0x0,0x0,0x0,0x0,0x34003400,0x34003400,0x0,0x0
.long 0x0,0x0,0x0,0x0,0xad64b33b,0x33882ed7,0xb388aed7,0xad64b33b
.long 0x0,0x0,0x0,0x0,0xb22f3113,0x322fb113,0x3113322f,0xb113b22f
.long 0x0,0x0,0x0,0x0,0x32ddabc6,0x301db3c3,0x301db3c3,0xb2dd2bc6
.long 0x0,0x0,0x0,0x0,0x2a3eaa3e,0x2a3eaa3e,0xb3d933d9,0xb3d933d9
.long 0x0,0x0,0x0,0x0,0xb3ea30c4,0xa8b2326d,0x28b2b26d,0xb3ea30c4
.long 0x0,0x0,0x0,0x0,0x2f8bb30e,0xaf8b330e,0x330e2f8b,0xb30eaf8b
.long 0x0,0x0,0x0,0x0,0x315f33fe,0xb1eda248,0xb1eda248,0xb15fb3fe
.long 0x80008000,0x80008000,0x34003400,0x34003400,0x0,0x0,0x0,0x0
.long 0xb33bad64,0xaed7b388,0x2ed73388,0xb33bad64,0x0,0x0,0x0,0x0
.long 0xb22fb113,0x322f3113,0xb113322f,0x3113b22f,0x0,0x0,0x0,0x0
.long 0x2bc6b2dd,0xb3c3301d,0xb3c3301d,0xabc632dd,0x0,0x0,0x0,0x0
.long 0x33d9b3d9,0x33d9b3d9,0xaa3e2a3e,0xaa3e2a3e,0x0,0x0,0x0,0x0
.long 0x30c4b3ea,0xb26d28b2,0x326da8b2,0x30c4b3ea,0x0,0x0,0x0,0x0
.long 0xaf8bb30e,0x2f8b330e,0x330eaf8b,0xb30e2f8b,0x0,0x0,0x0,0x0
.long 0xb3feb15f,0xa248b1ed,0xa248b1ed,0x33fe315f,0x0,0x0,0x0,0x0
.long 0x80008000,0x80008000,0x34003400,0x34003400,0x0,0x0,0x0,0x0
.long 0x333b2d64,0x2ed73388,0xaed7b388,0x333b2d64,0x0,0x0,0x0,0x0
.long 0xb22fb113,0x322f3113,0xb113322f,0x3113b22f,0x0,0x0,0x0,0x0
.long 0xabc632dd,0x33c3b01d,0x33c3b01d,0x2bc6b2dd,0x0,0x0,0x0,0x0
.long 0x33d9b3d9,0x33d9b3d9,0xaa3e2a3e,0xaa3e2a3e,0x0,0x0,0x0,0x0
.long 0xb0c433ea,0x326da8b2,0xb26d28b2,0xb0c433ea,0x0,0x0,0x0,0x0
.long 0xaf8bb30e,0x2f8b330e,0x330eaf8b,0xb30e2f8b,0x0,0x0,0x0,0x0
.long 0x33fe315f,0x224831ed,0x224831ed,0xb3feb15f,0x0,0x0,0x0,0x0
.long 0x0,0x0,0x0,0x0,0x80008000,0x80008000,0x34003400,0x34003400
.long 0x0,0x0,0x0,0x0,0xb388aed7,0xad64b33b,0x2d64333b,0xb388aed7
.long 0x0,0x0,0x0,0x0,0xb113b22f,0x3113322f,0xb22f3113,0x322fb113
.long 0x0,0x0,0x0,0x0,0x301db3c3,0xb2dd2bc6,0xb2dd2bc6,0xb01d33c3
.long 0x0,0x0,0x0,0x0,0x33d9b3d9,0x33d9b3d9,0x2a3eaa3e,0x2a3eaa3e
.long 0x0,0x0,0x0,0x0,0x28b2b26d,0xb3ea30c4,0x33eab0c4,0x28b2b26d
.long 0x0,0x0,0x0,0x0,0xb30eaf8b,0x330e2f8b,0x2f8bb30e,0xaf8b330e
.long 0x0,0x0,0x0,0x0,0xb1eda248,0xb15fb3fe,0xb15fb3fe,0x31ed2248
.long 0x0,0x0,0x0,0x0,0x80008000,0x80008000,0x34003400,0x34003400
.long 0x0,0x0,0x0,0x0,0x33882ed7,0x2d64333b,0xad64b33b,0x33882ed7
.long 0x0,0x0,0x0,0x0,0xb113b22f,0x3113322f,0xb22f3113,0x322fb113
.long 0x0,0x0,0x0,0x0,0xb01d33c3,0x32ddabc6,0x32ddabc6,0x301db3c3
.long 0x0,0x0,0x0,0x0,0x33d9b3d9,0x33d9b3d9,0x2a3eaa3e,0x2a3eaa3e
.long 0x0,0x0,0x0,0x0,0xa8b2326d,0x33eab0c4,0xb3ea30c4,0xa8b2326d
.long 0x0,0x0,0x0,0x0,0xb30eaf8b,0x330e2f8b,0x2f8bb30e,0xaf8b330e
.long 0x0,0x0,0x0,0x0,0x31ed2248,0x315f33fe,0x315f33fe,0xb1eda248
.long 0x12a000,0x0,0x0,0x0,0x12c800,0x0,0x0,0x0
.long 0x12f000,0x0,0x0,0x0,0x131800,0x0,0x0,0x0
.long 0x134000,0x0,0x0,0x0,0x136800,0x0,0x0,0x0
.long 0x139000,0x0,0x0,0x0,0x13b800,0x0,0x0,0x0
.long 0x13e000,0x0,0x0,0x0,0x140800,0x0,0x0,0x0
.long 0x143000,0x0,0x0,0x0,0x145800,0x0,0x0,0x0
.long 0x148000,0x0,0x0,0x0,0x14a800,0x0,0x0,0x0
.long 0x14d000,0x0,0x0,0x0,0x14f800,0x0,0x0,0x0
.long 0x12b400,0x0,0x0,0x0,0x12dc00,0x0,0x0,0x0
.long 0x130400,0x0,0x0,0x0,0x132c00,0x0,0x0,0x0
.long 0x135400,0x0,0x0,0x0,0x137c00,0x0,0x0,0x0
.long 0x13a400,0x0,0x0,0x0,0x13cc00,0x0,0x0,0x0
.long 0x13f400,0x0,0x0,0x0,0x141c00,0x0,0x0,0x0
.long 0x144400,0x0,0x0,0x0,0x146c00,0x0,0x0,0x0
.long 0x149400,0x0,0x0,0x0,0x14bc00,0x0,0x0,0x0
.long 0x14e400,0x0,0x0,0x0,0x150c00,0x0,0x0,0x0
.long 0x14f810,0x0,0x0,0x0,0x14d010,0x0,0x0,0x0
.long 0x14a810,0x0,0x0,0x0,0x148010,0x0,0x0,0x0
.long 0x145810,0x0,0x0,0x0,0x143010,0x0,0x0,0x0
.long 0x140810,0x0,0x0,0x0,0x13e010,0x0,0x0,0x0
.long 0x13b810,0x0,0x0,0x0,0x139010,0x0,0x0,0x0
.long 0x136810,0x0,0x0,0x0,0x134010,0x0,0x0,0x0
.long 0x131810,0x0,0x0,0x0,0x12f010,0x0,0x0,0x0
.long 0x12c810,0x0,0x0,0x0,0x12a010,0x0,0x0,0x0
.long 0x150c10,0x0,0x0,0x0,0x14e410,0x0,0x0,0x0
.long 0x14bc10,0x0,0x0,0x0,0x149410,0x0,0x0,0x0
.long 0x146c10,0x0,0x0,0x0,0x144410,0x0,0x0,0x0
.long 0x141c10,0x0,0x0,0x0,0x13f410,0x0,0x0,0x0
.long 0x13cc10,0x0,0x0,0x0,0x13a410,0x0,0x0,0x0
.long 0x137c10,0x0,0x0,0x0,0x135410,0x0,0x0,0x0
.long 0x132c10,0x0,0x0,0x0,0x130410,0x0,0x0,0x0
.long 0x12dc10,0x0,0x0,0x0,0x12b410,0x0,0x0,0x0
.long 0x5c00,0x5c00,0x0,0x0,0x5c008000,0x5c008000,0x0,0x0
.long 0x5c00,0x5c00,0x0,0x0,0x5c008000,0x5c008000,0x0,0x0
.long 0x5c00,0x5c00,0x0,0x0,0x5c008000,0x5c008000,0x0,0x0
.long 0x5c00,0x5c00,0x0,0x0,0x5c008000,0x5c008000,0x0,0x0
.long 0x0,0x0,0x5c008000,0xdc008000,0x0,0x0,0x5c00,0xdc00
.long 0x0,0x0,0x5c008000,0xdc008000,0x0,0x0,0x5c00,0xdc00
.long 0x0,0x0,0x5c008000,0xdc008000,0x0,0x0,0x5c00,0xdc00
.long 0x0,0x0,0x5c008000,0xdc008000,0x0,0x0,0x5c00,0xdc00
.long 0x5c00,0x5c00,0x0,0x0,0x5c008000,0x5c008000,0x0,0x0
.long 0x59a859a8,0xd9a859a8,0x0,0x0,0x59a8d9a8,0x59a859a8,0x0,0x0
.long 0x5c000000,0xdc008000,0x0,0x0,0xdc00,0x80005c00,0x0,0x0
.long 0x59a8d9a8,0xd9a8d9a8,0x0,0x0,0xd9a8d9a8,0xd9a859a8,0x0,0x0
.long 0x0,0x0,0x5b64561f,0x5b64d61f,0x0,0x0,0xd61f5b64,0x561f5b64
.long 0x0,0x0,0x561f5b64,0x561fdb64,0x0,0x0,0xdb64561f,0x5b64561f
.long 0x0,0x0,0xd61f5b64,0xd61fdb64,0x0,0x0,0xdb64d61f,0x5b64d61f
.long 0x0,0x0,0xdb64561f,0xdb64d61f,0x0,0x0,0xd61fdb64,0x561fdb64
.long 0x5c00,0x5c00,0x0,0x0,0x5c008000,0x5c008000,0x0,0x0
.long 0x5c000000,0xdc008000,0x0,0x0,0xdc00,0x80005c00,0x0,0x0
.long 0xdc00,0xdc00,0x0,0x0,0xdc008000,0xdc008000,0x0,0x0
.long 0xdc008000,0x5c000000,0x0,0x0,0x80005c00,0xdc00,0x0,0x0
.long 0x0,0x0,0x59a859a8,0x59a8d9a8,0x0,0x0,0xd9a859a8,0x59a859a8
.long 0x0,0x0,0xd9a859a8,0xd9a8d9a8,0x0,0x0,0xd9a8d9a8,0x59a8d9a8
.long 0x0,0x0,0xd9a8d9a8,0xd9a859a8,0x0,0x0,0x59a8d9a8,0xd9a8d9a8
.long 0x0,0x0,0x59a8d9a8,0x59a859a8,0x0,0x0,0x59a859a8,0xd9a859a8
.long 0x5c00,0x5c00,0x0,0x0,0x5c008000,0x5c008000,0x0,0x0
.long 0x59a8d9a8,0xd9a8d9a8,0x0,0x0,0xd9a8d9a8,0xd9a859a8,0x0,0x0
.long 0xdc008000,0x5c000000,0x0,0x0,0x80005c00,0xdc00,0x0,0x0
.long 0x59a859a8,0xd9a859a8,0x0,0x0,0x59a8d9a8,0x59a859a8,0x0,0x0
.long 0x0,0x0,0x561f5b64,0x561fdb64,0x0,0x0,0xdb64561f,0x5b64561f
.long 0x0,0x0,0xdb64d61f,0xdb64561f,0x0,0x0,0x561fdb64,0xd61fdb64
.long 0x0,0x0,0x5b64d61f,0x5b64561f,0x0,0x0,0x561f5b64,0xd61f5b64
.long 0x0,0x0,0xd61f5b64,0xd61fdb64,0x0,0x0,0xdb64d61f,0x5b64d61f
.long 0x5c00,0x5c00,0x0,0x0,0x5c008000,0x5c008000,0x0,0x0
.long 0xdc00,0xdc00,0x0,0x0,0xdc008000,0xdc008000,0x0,0x0
.long 0x5c00,0x5c00,0x0,0x0,0x5c008000,0x5c008000,0x0,0x0
.long 0xdc00,0xdc00,0x0,0x0,0xdc008000,0xdc008000,0x0,0x0
.long 0x0,0x0,0x80005c00,0xdc00,0x0,0x0,0xdc008000,0x5c000000
.long 0x0,0x0,0xdc00,0x80005c00,0x0,0x0,0x5c000000,0xdc008000
.long 0x0,0x0,0x80005c00,0xdc00,0x0,0x0,0xdc008000,0x5c000000
.long 0x0,0x0,0xdc00,0x80005c00,0x0,0x0,0x5c000000,0xdc008000
.long 0x5c00,0x5c00,0x0,0x0,0x5c008000,0x5c008000,0x0,0x0
.long 0xd9a8d9a8,0x59a8d9a8,0x0,0x0,0xd9a859a8,0xd9a8d9a8,0x0,0x0
.long 0x5c000000,0xdc008000,0x0,0x0,0xdc00,0x80005c00,0x0,0x0
.long 0xd9a859a8,0x59a859a8,0x0,0x0,0x59a859a8,0x59a8d9a8,0x0,0x0
.long 0x0,0x0,0xd61f5b64,0xd61fdb64,0x0,0x0,0xdb64d61f,0x5b64d61f
.long 0x0,0x0,0x5b64d61f,0x5b64561f,0x0,0x0,0x561f5b64,0xd61f5b64
.long 0x0,0x0,0xdb64d61f,0xdb64561f,0x0,0x0,0x561fdb64,0xd61fdb64
.long 0x0,0x0,0x561f5b64,0x561fdb64,0x0,0x0,0xdb64561f,0x5b64561f
.long 0x5c00,0x5c00,0x0,0x0,0x5c008000,0x5c008000,0x0,0x0
.long 0xdc008000,0x5c000000,0x0,0x0,0x80005c00,0xdc00,0x0,0x0
.long 0xdc00,0xdc00,0x0,0x0,0xdc008000,0xdc008000,0x0,0x0
.long 0x5c000000,0xdc008000,0x0,0x0,0xdc00,0x80005c00,0x0,0x0
.long 0x0,0x0,0xd9a859a8,0xd9a8d9a8,0x0,0x0,0xd9a8d9a8,0x59a8d9a8
.long 0x0,0x0,0x59a859a8,0x59a8d9a8,0x0,0x0,0xd9a859a8,0x59a859a8
.long 0x0,0x0,0x59a8d9a8,0x59a859a8,0x0,0x0,0x59a859a8,0xd9a859a8
.long 0x0,0x0,0xd9a8d9a8,0xd9a859a8,0x0,0x0,0x59a8d9a8,0xd9a8d9a8
.long 0x5c00,0x5c00,0x0,0x0,0x5c008000,0x5c008000,0x0,0x0
.long 0xd9a859a8,0x59a859a8,0x0,0x0,0x59a859a8,0x59a8d9a8,0x0,0x0
.long 0xdc008000,0x5c000000,0x0,0x0,0x80005c00,0xdc00,0x0,0x0
.long 0xd9a8d9a8,0x59a8d9a8,0x0,0x0,0xd9a859a8,0xd9a8d9a8,0x0,0x0
.long 0x0,0x0,0xdb64561f,0xdb64d61f,0x0,0x0,0xd61fdb64,0x561fdb64
.long 0x0,0x0,0xd61f5b64,0xd61fdb64,0x0,0x0,0xdb64d61f,0x5b64d61f
.long 0x0,0x0,0x561f5b64,0x561fdb64,0x0,0x0,0xdb64561f,0x5b64561f
.long 0x0,0x0,0x5b64561f,0x5b64d61f,0x0,0x0,0xd61f5b64,0x561f5b64
.long 0x5c00,0x5c00,0x0,0x0,0x5c008000,0x5c008000,0x0,0x0
.long 0x5c00,0x5c00,0x0,0x0,0x5c008000,0x5c008000,0x0,0x0
.long 0x5c00,0x5c00,0x0,0x0,0x5c008000,0x5c008000,0x0,0x0
.long 0x5c00,0x5c00,0x0,0x0,0x5c008000,0x5c008000,0x0,0x0
.long 0x0,0x0,0x5c008000,0xdc008000,0x0,0x0,0x5c00,0xdc00
.long 0x0,0x0,0x5c008000,0xdc008000,0x0,0x0,0x5c00,0xdc00
.long 0x0,0x0,0x5c008000,0xdc008000,0x0,0x0,0x5c00,0xdc00
.long 0x0,0x0,0x5c008000,0xdc008000,0x0,0x0,0x5c00,0xdc00
.long 0xdc00,0xdc00,0x0,0x0,0xdc008000,0xdc008000,0x0,0x0
.long 0xd9a8d9a8,0x59a8d9a8,0x0,0x0,0xd9a859a8,0xd9a8d9a8,0x0,0x0
.long 0xdc008000,0x5c000000,0x0,0x0,0x80005c00,0xdc00,0x0,0x0
.long 0xd9a859a8,0x59a859a8,0x0,0x0,0x59a859a8,0x59a8d9a8,0x0,0x0
.long 0x0,0x0,0xdb64d61f,0xdb64561f,0x0,0x0,0x561fdb64,0xd61fdb64
.long 0x0,0x0,0xd61fdb64,0xd61f5b64,0x0,0x0,0x5b64d61f,0xdb64d61f
.long 0x0,0x0,0x561fdb64,0x561f5b64,0x0,0x0,0x5b64561f,0xdb64561f
.long 0x0,0x0,0x5b64d61f,0x5b64561f,0x0,0x0,0x561f5b64,0xd61f5b64
.long 0x5c00,0x5c00,0x0,0x0,0x5c008000,0x5c008000,0x0,0x0
.long 0x5c000000,0xdc008000,0x0,0x0,0xdc00,0x80005c00,0x0,0x0
.long 0xdc00,0xdc00,0x0,0x0,0xdc008000,0xdc008000,0x0,0x0
.long 0xdc008000,0x5c000000,0x0,0x0,0x80005c00,0xdc00,0x0,0x0
.long 0x0,0x0,0x59a859a8,0x59a8d9a8,0x0,0x0,0xd9a859a8,0x59a859a8
.long 0x0,0x0,0xd9a859a8,0xd9a8d9a8,0x0,0x0,0xd9a8d9a8,0x59a8d9a8
.long 0x0,0x0,0xd9a8d9a8,0xd9a859a8,0x0,0x0,0x59a8d9a8,0xd9a8d9a8
.long 0x0,0x0,0x59a8d9a8,0x59a859a8,0x0,0x0,0x59a859a8,0xd9a859a8
.long 0xdc00,0xdc00,0x0,0x0,0xdc008000,0xdc008000,0x0,0x0
.long 0xd9a859a8,0x59a859a8,0x0,0x0,0x59a859a8,0x59a8d9a8,0x0,0x0
.long 0x5c000000,0xdc008000,0x0,0x0,0xdc00,0x80005c00,0x0,0x0
.long 0xd9a8d9a8,0x59a8d9a8,0x0,0x0,0xd9a859a8,0xd9a8d9a8,0x0,0x0
.long 0x0,0x0,0xd61fdb64,0xd61f5b64,0x0,0x0,0x5b64d61f,0xdb64d61f
.long 0x0,0x0,0x5b64561f,0x5b64d61f,0x0,0x0,0xd61f5b64,0x561f5b64
.long 0x0,0x0,0xdb64561f,0xdb64d61f,0x0,0x0,0xd61fdb64,0x561fdb64
.long 0x0,0x0,0x561fdb64,0x561f5b64,0x0,0x0,0x5b64561f,0xdb64561f
.long 0x5c00,0x5c00,0x0,0x0,0x5c008000,0x5c008000,0x0,0x0
.long 0xdc00,0xdc00,0x0,0x0,0xdc008000,0xdc008000,0x0,0x0
.long 0x5c00,0x5c00,0x0,0x0,0x5c008000,0x5c008000,0x0,0x0
.long 0xdc00,0xdc00,0x0,0x0,0xdc008000,0xdc008000,0x0,0x0
.long 0x0,0x0,0x80005c00,0xdc00,0x0,0x0,0xdc008000,0x5c000000
.long 0x0,0x0,0xdc00,0x80005c00,0x0,0x0,0x5c000000,0xdc008000
.long 0x0,0x0,0x80005c00,0xdc00,0x0,0x0,0xdc008000,0x5c000000
.long 0x0,0x0,0xdc00,0x80005c00,0x0,0x0,0x5c000000,0xdc008000
.long 0xdc00,0xdc00,0x0,0x0,0xdc008000,0xdc008000,0x0,0x0
.long 0x59a859a8,0xd9a859a8,0x0,0x0,0x59a8d9a8,0x59a859a8,0x0,0x0
.long 0xdc008000,0x5c000000,0x0,0x0,0x80005c00,0xdc00,0x0,0x0
.long 0x59a8d9a8,0xd9a8d9a8,0x0,0x0,0xd9a8d9a8,0xd9a859a8,0x0,0x0
.long 0x0,0x0,0x561fdb64,0x561f5b64,0x0,0x0,0x5b64561f,0xdb64561f
.long 0x0,0x0,0xdb64561f,0xdb64d61f,0x0,0x0,0xd61fdb64,0x561fdb64
.long 0x0,0x0,0x5b64561f,0x5b64d61f,0x0,0x0,0xd61f5b64,0x561f5b64
.long 0x0,0x0,0xd61fdb64,0xd61f5b64,0x0,0x0,0x5b64d61f,0xdb64d61f
.long 0x5c00,0x5c00,0x0,0x0,0x5c008000,0x5c008000,0x0,0x0
.long 0xdc008000,0x5c000000,0x0,0x0,0x80005c00,0xdc00,0x0,0x0
.long 0xdc00,0xdc00,0x0,0x0,0xdc008000,0xdc008000,0x0,0x0
.long 0x5c000000,0xdc008000,0x0,0x0,0xdc00,0x80005c00,0x0,0x0
.long 0x0,0x0,0xd9a859a8,0xd9a8d9a8,0x0,0x0,0xd9a8d9a8,0x59a8d9a8
.long 0x0,0x0,0x59a859a8,0x59a8d9a8,0x0,0x0,0xd9a859a8,0x59a859a8
.long 0x0,0x0,0x59a8d9a8,0x59a859a8,0x0,0x0,0x59a859a8,0xd9a859a8
.long 0x0,0x0,0xd9a8d9a8,0xd9a859a8,0x0,0x0,0x59a8d9a8,0xd9a8d9a8
.long 0xdc00,0xdc00,0x0,0x0,0xdc008000,0xdc008000,0x0,0x0
.long 0x59a8d9a8,0xd9a8d9a8,0x0,0x0,0xd9a8d9a8,0xd9a859a8,0x0,0x0
.long 0x5c000000,0xdc008000,0x0,0x0,0xdc00,0x80005c00,0x0,0x0
.long 0x59a859a8,0xd9a859a8,0x0,0x0,0x59a8d9a8,0x59a859a8,0x0,0x0
.long 0x0,0x0,0x5b64d61f,0x5b64561f,0x0,0x0,0x561f5b64,0xd61f5b64
.long 0x0,0x0,0x561fdb64,0x561f5b64,0x0,0x0,0x5b64561f,0xdb64561f
.long 0x0,0x0,0xd61fdb64,0xd61f5b64,0x0,0x0,0x5b64d61f,0xdb64d61f
.long 0x0,0x0,0xdb64d61f,0xdb64561f,0x0,0x0,0x561fdb64,0xd61fdb64
.long 0x0,0x0,0x5c00,0x5c00,0x0,0x0,0x5c008000,0x5c008000
.long 0x0,0x0,0x5c00,0x5c00,0x0,0x0,0x5c008000,0x5c008000
.long 0x0,0x0,0x5c00,0x5c00,0x0,0x0,0x5c008000,0x5c008000
.long 0x0,0x0,0x5c00,0x5c00,0x0,0x0,0x5c008000,0x5c008000
.long 0x5c008000,0xdc008000,0x0,0x0,0x5c00,0xdc00,0x0,0x0
.long 0x5c008000,0xdc008000,0x0,0x0,0x5c00,0xdc00,0x0,0x0
.long 0x5c008000,0xdc008000,0x0,0x0,0x5c00,0xdc00,0x0,0x0
.long 0x5c008000,0xdc008000,0x0,0x0,0x5c00,0xdc00,0x0,0x0
.long 0x0,0x0,0x5c00,0x5c00,0x0,0x0,0x5c008000,0x5c008000
.long 0x0,0x0,0x59a859a8,0xd9a859a8,0x0,0x0,0x59a8d9a8,0x59a859a8
.long 0x0,0x0,0x5c000000,0xdc008000,0x0,0x0,0xdc00,0x80005c00
.long 0x0,0x0,0x59a8d9a8,0xd9a8d9a8,0x0,0x0,0xd9a8d9a8,0xd9a859a8
.long 0x5b64561f,0x5b64d61f,0x0,0x0,0xd61f5b64,0x561f5b64,0x0,0x0
.long 0x561f5b64,0x561fdb64,0x0,0x0,0xdb64561f,0x5b64561f,0x0,0x0
.long 0xd61f5b64,0xd61fdb64,0x0,0x0,0xdb64d61f,0x5b64d61f,0x0,0x0
.long 0xdb64561f,0xdb64d61f,0x0,0x0,0xd61fdb64,0x561fdb64,0x0,0x0
.long 0x0,0x0,0x5c00,0x5c00,0x0,0x0,0x5c008000,0x5c008000
.long 0x0,0x0,0x5c000000,0xdc008000,0x0,0x0,0xdc00,0x80005c00
.long 0x0,0x0,0xdc00,0xdc00,0x0,0x0,0xdc008000,0xdc008000
.long 0x0,0x0,0xdc008000,0x5c000000,0x0,0x0,0x80005c00,0xdc00
.long 0x59a859a8,0x59a8d9a8,0x0,0x0,0xd9a859a8,0x59a859a8,0x0,0x0
.long 0xd9a859a8,0xd9a8d9a8,0x0,0x0,0xd9a8d9a8,0x59a8d9a8,0x0,0x0
.long 0xd9a8d9a8,0xd9a859a8,0x0,0x0,0x59a8d9a8,0xd9a8d9a8,0x0,0x0
.long 0x59a8d9a8,0x59a859a8,0x0,0x0,0x59a859a8,0xd9a859a8,0x0,0x0
.long 0x0,0x0,0x5c00,0x5c00,0x0,0x0,0x5c008000,0x5c008000
.long 0x0,0x0,0x59a8d9a8,0xd9a8d9a8,0x0,0x0,0xd9a8d9a8,0xd9a859a8
.long 0x0,0x0,0xdc008000,0x5c000000,0x0,0x0,0x80005c00,0xdc00
.long 0x0,0x0,0x59a859a8,0xd9a859a8,0x0,0x0,0x59a8d9a8,0x59a859a8
.long 0x561f5b64,0x561fdb64,0x0,0x0,0xdb64561f,0x5b64561f,0x0,0x0
.long 0xdb64d61f,0xdb64561f,0x0,0x0,0x561fdb64,0xd61fdb64,0x0,0x0
.long 0x5b64d61f,0x5b64561f,0x0,0x0,0x561f5b64,0xd61f5b64,0x0,0x0
.long 0xd61f5b64,0xd61fdb64,0x0,0x0,0xdb64d61f,0x5b64d61f,0x0,0x0
.long 0x0,0x0,0x5c00,0x5c00,0x0,0x0,0x5c008000,0x5c008000
.long 0x0,0x0,0xdc00,0xdc00,0x0,0x0,0xdc008000,0xdc008000
.long 0x0,0x0,0x5c00,0x5c00,0x0,0x0,0x5c008000,0x5c008000
.long 0x0,0x0,0xdc00,0xdc00,0x0,0x0,0xdc008000,0xdc008000
.long 0x80005c00,0xdc00,0x0,0x0,0xdc008000,0x5c000000,0x0,0x0
.long 0xdc00,0x80005c00,0x0,0x0,0x5c000000,0xdc008000,0x0,0x0
.long 0x80005c00,0xdc00,0x0,0x0,0xdc008000,0x5c000000,0x0,0x0
.long 0xdc00,0x80005c00,0x0,0x0,0x5c000000,0xdc008000,0x0,0x0
.long 0x0,0x0,0x5c00,0x5c00,0x0,0x0,0x5c008000,0x5c008000
.long 0x0,0x0,0xd9a8d9a8,0x59a8d9a8,0x0,0x0,0xd9a859a8,0xd9a8d9a8
.long 0x0,0x0,0x5c000000,0xdc008000,0x0,0x0,0xdc00,0x80005c00
.long 0x0,0x0,0xd9a859a8,0x59a859a8,0x0,0x0,0x59a859a8,0x59a8d9a8
.long 0xd61f5b64,0xd61fdb64,0x0,0x0,0xdb64d61f,0x5b64d61f,0x0,0x0
.long 0x5b64d61f,0x5b64561f,0x0,0x0,0x561f5b64,0xd61f5b64,0x0,0x0
.long 0xdb64d61f,0xdb64561f,0x0,0x0,0x561fdb64,0xd61fdb64,0x0,0x0
.long 0x561f5b64,0x561fdb64,0x0,0x0,0xdb64561f,0x5b64561f,0x0,0x0
.long 0x0,0x0,0x5c00,0x5c00,0x0,0x0,0x5c008000,0x5c008000
.long 0x0,0x0,0xdc008000,0x5c000000,0x0,0x0,0x80005c00,0xdc00
.long 0x0,0x0,0xdc00,0xdc00,0x0,0x0,0xdc008000,0xdc008000
.long 0x0,0x0,0x5c000000,0xdc008000,0x0,0x0,0xdc00,0x80005c00
.long 0xd9a859a8,0xd9a8d9a8,0x0,0x0,0xd9a8d9a8,0x59a8d9a8,0x0,0x0
.long 0x59a859a8,0x59a8d9a8,0x0,0x0,0xd9a859a8,0x59a859a8,0x0,0x0
.long 0x59a8d9a8,0x59a859a8,0x0,0x0,0x59a859a8,0xd9a859a8,0x0,0x0
.long 0xd9a8d9a8,0xd9a859a8,0x0,0x0,0x59a8d9a8,0xd9a8d9a8,0x0,0x0
.long 0x0,0x0,0x5c00,0x5c00,0x0,0x0,0x5c008000,0x5c008000
.long 0x0,0x0,0xd9a859a8,0x59a859a8,0x0,0x0,0x59a859a8,0x59a8d9a8
.long 0x0,0x0,0xdc008000,0x5c000000,0x0,0x0,0x80005c00,0xdc00
.long 0x0,0x0,0xd9a8d9a8,0x59a8d9a8,0x0,0x0,0xd9a859a8,0xd9a8d9a8
.long 0xdb64561f,0xdb64d61f,0x0,0x0,0xd61fdb64,0x561fdb64,0x0,0x0
.long 0xd61f5b64,0xd61fdb64,0x0,0x0,0xdb64d61f,0x5b64d61f,0x0,0x0
.long 0x561f5b64,0x561fdb64,0x0,0x0,0xdb64561f,0x5b64561f,0x0,0x0
.long 0x5b64561f,0x5b64d61f,0x0,0x0,0xd61f5b64,0x561f5b64,0x0,0x0
.long 0x0,0x0,0x5c00,0x5c00,0x0,0x0,0x5c008000,0x5c008000
.long 0x0,0x0,0x5c00,0x5c00,0x0,0x0,0x5c008000,0x5c008000
.long 0x0,0x0,0x5c00,0x5c00,0x0,0x0,0x5c008000,0x5c008000
.long 0x0,0x0,0x5c00,0x5c00,0x0,0x0,0x5c008000,0x5c008000
.long 0x5c008000,0xdc008000,0x0,0x0,0x5c00,0xdc00,0x0,0x0
.long 0x5c008000,0xdc008000,0x0,0x0,0x5c00,0xdc00,0x0,0x0
.long 0x5c008000,0xdc008000,0x0,0x0,0x5c00,0xdc00,0x0,0x0
.long 0x5c008000,0xdc008000,0x0,0x0,0x5c00,0xdc00,0x0,0x0
.long 0x0,0x0,0xdc00,0xdc00,0x0,0x0,0xdc008000,0xdc008000
.long 0x0,0x0,0xd9a8d9a8,0x59a8d9a8,0x0,0x0,0xd9a859a8,0xd9a8d9a8
.long 0x0,0x0,0xdc008000,0x5c000000,0x0,0x0,0x80005c00,0xdc00
.long 0x0,0x0,0xd9a859a8,0x59a859a8,0x0,0x0,0x59a859a8,0x59a8d9a8
.long 0xdb64d61f,0xdb64561f,0x0,0x0,0x561fdb64,0xd61fdb64,0x0,0x0
.long 0xd61fdb64,0xd61f5b64,0x0,0x0,0x5b64d61f,0xdb64d61f,0x0,0x0
.long 0x561fdb64,0x561f5b64,0x0,0x0,0x5b64561f,0xdb64561f,0x0,0x0
.long 0x5b64d61f,0x5b64561f,0x0,0x0,0x561f5b64,0xd61f5b64,0x0,0x0
.long 0x0,0x0,0x5c00,0x5c00,0x0,0x0,0x5c008000,0x5c008000
.long 0x0,0x0,0x5c000000,0xdc008000,0x0,0x0,0xdc00,0x80005c00
.long 0x0,0x0,0xdc00,0xdc00,0x0,0x0,0xdc008000,0xdc008000
.long 0x0,0x0,0xdc008000,0x5c000000,0x0,0x0,0x80005c00,0xdc00
.long 0x59a859a8,0x59a8d9a8,0x0,0x0,0xd9a859a8,0x59a859a8,0x0,0x0
.long 0xd9a859a8,0xd9a8d9a8,0x0,0x0,0xd9a8d9a8,0x59a8d9a8,0x0,0x0
.long 0xd9a8d9a8,0xd9a859a8,0x0,0x0,0x59a8d9a8,0xd9a8d9a8,0x0,0x0
.long 0x59a8d9a8,0x59a859a8,0x0,0x0,0x59a859a8,0xd9a859a8,0x0,0x0
.long 0x0,0x0,0xdc00,0xdc00,0x0,0x0,0xdc008000,0xdc008000
.long 0x0,0x0,0xd9a859a8,0x59a859a8,0x0,0x0,0x59a859a8,0x59a8d9a8
.long 0x0,0x0,0x5c000000,0xdc008000,0x0,0x0,0xdc00,0x80005c00
.long 0x0,0x0,0xd9a8d9a8,0x59a8d9a8,0x0,0x0,0xd9a859a8,0xd9a8d9a8
.long 0xd61fdb64,0xd61f5b64,0x0,0x0,0x5b64d61f,0xdb64d61f,0x0,0x0
.long 0x5b64561f,0x5b64d61f,0x0,0x0,0xd61f5b64,0x561f5b64,0x0,0x0
.long 0xdb64561f,0xdb64d61f,0x0,0x0,0xd61fdb64,0x561fdb64,0x0,0x0
.long 0x561fdb64,0x561f5b64,0x0,0x0,0x5b64561f,0xdb64561f,0x0,0x0
.long 0x0,0x0,0x5c00,0x5c00,0x0,0x0,0x5c008000,0x5c008000
.long 0x0,0x0,0xdc00,0xdc00,0x0,0x0,0xdc008000,0xdc008000
.long 0x0,0x0,0x5c00,0x5c00,0x0,0x0,0x5c008000,0x5c008000
.long 0x0,0x0,0xdc00,0xdc00,0x0,0x0,0xdc008000,0xdc008000
.long 0x80005c00,0xdc00,0x0,0x0,0xdc008000,0x5c000000,0x0,0x0
.long 0xdc00,0x80005c00,0x0,0x0,0x5c000000,0xdc008000,0x0,0x0
.long 0x80005c00,0xdc00,0x0,0x0,0xdc008000,0x5c000000,0x0,0x0
.long 0xdc00,0x80005c00,0x0,0x0,0x5c000000,0xdc008000,0x0,0x0
.long 0x0,0x0,0xdc00,0xdc00,0x0,0x0,0xdc008000,0xdc008000
.long 0x0,0x0,0x59a859a8,0xd9a859a8,0x0,0x0,0x59a8d9a8,0x59a859a8
.long 0x0,0x0,0xdc008000,0x5c000000,0x0,0x0,0x80005c00,0xdc00
.long 0x0,0x0,0x59a8d9a8,0xd9a8d9a8,0x0,0x0,0xd9a8d9a8,0xd9a859a8
.long 0x561fdb64,0x561f5b64,0x0,0x0,0x5b64561f,0xdb64561f,0x0,0x0
.long 0xdb64561f,0xdb64d61f,0x0,0x0,0xd61fdb64,0x561fdb64,0x0,0x0
.long 0x5b64561f,0x5b64d61f,0x0,0x0,0xd61f5b64,0x561f5b64,0x0,0x0
.long 0xd61fdb64,0xd61f5b64,0x0,0x0,0x5b64d61f,0xdb64d61f,0x0,0x0
.long 0x0,0x0,0x5c00,0x5c00,0x0,0x0,0x5c008000,0x5c008000
.long 0x0,0x0,0xdc008000,0x5c000000,0x0,0x0,0x80005c00,0xdc00
.long 0x0,0x0,0xdc00,0xdc00,0x0,0x0,0xdc008000,0xdc008000
.long 0x0,0x0,0x5c000000,0xdc008000,0x0,0x0,0xdc00,0x80005c00
.long 0xd9a859a8,0xd9a8d9a8,0x0,0x0,0xd9a8d9a8,0x59a8d9a8,0x0,0x0
.long 0x59a859a8,0x59a8d9a8,0x0,0x0,0xd9a859a8,0x59a859a8,0x0,0x0
.long 0x59a8d9a8,0x59a859a8,0x0,0x0,0x59a859a8,0xd9a859a8,0x0,0x0
.long 0xd9a8d9a8,0xd9a859a8,0x0,0x0,0x59a8d9a8,0xd9a8d9a8,0x0,0x0
.long 0x0,0x0,0xdc00,0xdc00,0x0,0x0,0xdc008000,0xdc008000
.long 0x0,0x0,0x59a8d9a8,0xd9a8d9a8,0x0,0x0,0xd9a8d9a8,0xd9a859a8
.long 0x0,0x0,0x5c000000,0xdc008000,0x0,0x0,0xdc00,0x80005c00
.long 0x0,0x0,0x59a859a8,0xd9a859a8,0x0,0x0,0x59a8d9a8,0x59a859a8
.long 0x5b64d61f,0x5b64561f,0x0,0x0,0x561f5b64,0xd61f5b64,0x0,0x0
.long 0x561fdb64,0x561f5b64,0x0,0x0,0x5b64561f,0xdb64561f,0x0,0x0
.long 0xd61fdb64,0xd61f5b64,0x0,0x0,0x5b64d61f,0xdb64d61f,0x0,0x0
.long 0xdb64d61f,0xdb64561f,0x0,0x0,0x561fdb64,0xd61fdb64,0x0,0x0
.long 0x5c00,0x5c00,0x0,0x0,0x5c008000,0x5c008000,0x0,0x0
.long 0x5c00,0x5c00,0x0,0x0,0x5c008000,0x5c008000,0x0,0x0
.long 0x5c00,0x5c00,0x0,0x0,0x5c008000,0x5c008000,0x0,0x0
.long 0x5c00,0x5c00,0x0,0x0,0x5c008000,0x5c008000,0x0,0x0
.long 0x5c00,0x5c00,0x0,0x0,0x5c008000,0x5c008000,0x0,0x0
.long 0x5c008000,0x5c008000,0x0,0x0,0x5c00,0x5c00,0x0,0x0
.long 0x5c008000,0x5c008000,0x0,0x0,0x5c00,0x5c00,0x0,0x0
.long 0x5c008000,0x5c008000,0x0,0x0,0x5c00,0x5c00,0x0,0x0
.long 0x5c00,0x5c00,0x0,0x0,0x5c008000,0x5c008000,0x0,0x0
.long 0x59a859a8,0xd9a859a8,0x0,0x0,0x59a8d9a8,0x59a859a8,0x0,0x0
.long 0x5c000000,0xdc008000,0x0,0x0,0xdc00,0x80005c00,0x0,0x0
.long 0x59a8d9a8,0xd9a8d9a8,0x0,0x0,0xd9a8d9a8,0xd9a859a8,0x0,0x0
.long 0xdc00,0xdc00,0x0,0x0,0xdc008000,0xdc008000,0x0,0x0
.long 0xd9a859a8,0xd9a8d9a8,0x0,0x0,0xd9a8d9a8,0x59a8d9a8,0x0,0x0
.long 0x80005c00,0xdc00,0x0,0x0,0xdc008000,0x5c000000,0x0,0x0
.long 0x59a859a8,0x59a8d9a8,0x0,0x0,0xd9a859a8,0x59a859a8,0x0,0x0
.long 0x5c00,0x5c00,0x0,0x0,0x5c008000,0x5c008000,0x0,0x0
.long 0x5c000000,0xdc008000,0x0,0x0,0xdc00,0x80005c00,0x0,0x0
.long 0xdc00,0xdc00,0x0,0x0,0xdc008000,0xdc008000,0x0,0x0
.long 0xdc008000,0x5c000000,0x0,0x0,0x80005c00,0xdc00,0x0,0x0
.long 0x5c00,0x5c00,0x0,0x0,0x5c008000,0x5c008000,0x0,0x0
.long 0xdc00,0x80005c00,0x0,0x0,0x5c000000,0xdc008000,0x0,0x0
.long 0xdc008000,0xdc008000,0x0,0x0,0xdc00,0xdc00,0x0,0x0
.long 0x80005c00,0xdc00,0x0,0x0,0xdc008000,0x5c000000,0x0,0x0
.long 0x5c00,0x5c00,0x0,0x0,0x5c008000,0x5c008000,0x0,0x0
.long 0x59a8d9a8,0xd9a8d9a8,0x0,0x0,0xd9a8d9a8,0xd9a859a8,0x0,0x0
.long 0xdc008000,0x5c000000,0x0,0x0,0x80005c00,0xdc00,0x0,0x0
.long 0x59a859a8,0xd9a859a8,0x0,0x0,0x59a8d9a8,0x59a859a8,0x0,0x0
.long 0xdc00,0xdc00,0x0,0x0,0xdc008000,0xdc008000,0x0,0x0
.long 0x59a859a8,0x59a8d9a8,0x0,0x0,0xd9a859a8,0x59a859a8,0x0,0x0
.long 0xdc00,0x80005c00,0x0,0x0,0x5c000000,0xdc008000,0x0,0x0
.long 0xd9a859a8,0xd9a8d9a8,0x0,0x0,0xd9a8d9a8,0x59a8d9a8,0x0,0x0
.long 0x5c00,0x5c00,0x0,0x0,0x5c008000,0x5c008000,0x0,0x0
.long 0xdc00,0xdc00,0x0,0x0,0xdc008000,0xdc008000,0x0,0x0
.long 0x5c00,0x5c00,0x0,0x0,0x5c008000,0x5c008000,0x0,0x0
.long 0xdc00,0xdc00,0x0,0x0,0xdc008000,0xdc008000,0x0,0x0
.long 0x5c00,0x5c00,0x0,0x0,0x5c008000,0x5c008000,0x0,0x0
.long 0xdc008000,0xdc008000,0x0,0x0,0xdc00,0xdc00,0x0,0x0
.long 0x5c008000,0x5c008000,0x0,0x0,0x5c00,0x5c00,0x0,0x0
.long 0xdc008000,0xdc008000,0x0,0x0,0xdc00,0xdc00,0x0,0x0
.long 0x5c00,0x5c00,0x0,0x0,0x5c008000,0x5c008000,0x0,0x0
.long 0xd9a8d9a8,0x59a8d9a8,0x0,0x0,0xd9a859a8,0xd9a8d9a8,0x0,0x0
.long 0x5c000000,0xdc008000,0x0,0x0,0xdc00,0x80005c00,0x0,0x0
.long 0xd9a859a8,0x59a859a8,0x0,0x0,0x59a859a8,0x59a8d9a8,0x0,0x0
.long 0xdc00,0xdc00,0x0,0x0,0xdc008000,0xdc008000,0x0,0x0
.long 0x59a8d9a8,0x59a859a8,0x0,0x0,0x59a859a8,0xd9a859a8,0x0,0x0
.long 0x80005c00,0xdc00,0x0,0x0,0xdc008000,0x5c000000,0x0,0x0
.long 0xd9a8d9a8,0xd9a859a8,0x0,0x0,0x59a8d9a8,0xd9a8d9a8,0x0,0x0
.long 0x5c00,0x5c00,0x0,0x0,0x5c008000,0x5c008000,0x0,0x0
.long 0xdc008000,0x5c000000,0x0,0x0,0x80005c00,0xdc00,0x0,0x0
.long 0xdc00,0xdc00,0x0,0x0,0xdc008000,0xdc008000,0x0,0x0
.long 0x5c000000,0xdc008000,0x0,0x0,0xdc00,0x80005c00,0x0,0x0
.long 0x5c00,0x5c00,0x0,0x0,0x5c008000,0x5c008000,0x0,0x0
.long 0x80005c00,0xdc00,0x0,0x0,0xdc008000,0x5c000000,0x0,0x0
.long 0xdc008000,0xdc008000,0x0,0x0,0xdc00,0xdc00,0x0,0x0
.long 0xdc00,0x80005c00,0x0,0x0,0x5c000000,0xdc008000,0x0,0x0
.long 0x5c00,0x5c00,0x0,0x0,0x5c008000,0x5c008000,0x0,0x0
.long 0xd9a859a8,0x59a859a8,0x0,0x0,0x59a859a8,0x59a8d9a8,0x0,0x0
.long 0xdc008000,0x5c000000,0x0,0x0,0x80005c00,0xdc00,0x0,0x0
.long 0xd9a8d9a8,0x59a8d9a8,0x0,0x0,0xd9a859a8,0xd9a8d9a8,0x0,0x0
.long 0xdc00,0xdc00,0x0,0x0,0xdc008000,0xdc008000,0x0,0x0
.long 0xd9a8d9a8,0xd9a859a8,0x0,0x0,0x59a8d9a8,0xd9a8d9a8,0x0,0x0
.long 0xdc00,0x80005c00,0x0,0x0,0x5c000000,0xdc008000,0x0,0x0
.long 0x59a8d9a8,0x59a859a8,0x0,0x0,0x59a859a8,0xd9a859a8,0x0,0x0
.long 0x5c00,0xdc00,0x0,0x0,0x5c008000,0xdc008000,0x0,0x0
.long 0x5c00,0xdc00,0x0,0x0,0x5c008000,0xdc008000,0x0,0x0
.long 0x5c00,0xdc00,0x0,0x0,0x5c008000,0xdc008000,0x0,0x0
.long 0x5c00,0xdc00,0x0,0x0,0x5c008000,0xdc008000,0x0,0x0
.long 0x5c008000,0xdc008000,0x0,0x0,0x5c00,0xdc00,0x0,0x0
.long 0x5c008000,0xdc008000,0x0,0x0,0x5c00,0xdc00,0x0,0x0
.long 0x5c008000,0xdc008000,0x0,0x0,0x5c00,0xdc00,0x0,0x0
.long 0x5c008000,0xdc008000,0x0,0x0,0x5c00,0xdc00,0x0,0x0
.long 0xd61f5b64,0x561f5b64,0x0,0x0,0x5b64561f,0x5b64d61f,0x0,0x0
.long 0xdb64561f,0x5b64561f,0x0,0x0,0x561f5b64,0x561fdb64,0x0,0x0
.long 0xdb64d61f,0x5b64d61f,0x0,0x0,0xd61f5b64,0xd61fdb64,0x0,0x0
.long 0xd61fdb64,0x561fdb64,0x0,0x0,0xdb64561f,0xdb64d61f,0x0,0x0
.long 0xdb64d61f,0xdb64561f,0x0,0x0,0x561fdb64,0xd61fdb64,0x0,0x0
.long 0xd61fdb64,0xd61f5b64,0x0,0x0,0x5b64d61f,0xdb64d61f,0x0,0x0
.long 0x561fdb64,0x561f5b64,0x0,0x0,0x5b64561f,0xdb64561f,0x0,0x0
.long 0x5b64d61f,0x5b64561f,0x0,0x0,0x561f5b64,0xd61f5b64,0x0,0x0
.long 0xd9a859a8,0x59a859a8,0x0,0x0,0x59a859a8,0x59a8d9a8,0x0,0x0
.long 0xd9a8d9a8,0x59a8d9a8,0x0,0x0,0xd9a859a8,0xd9a8d9a8,0x0,0x0
.long 0x59a8d9a8,0xd9a8d9a8,0x0,0x0,0xd9a8d9a8,0xd9a859a8,0x0,0x0
.long 0x59a859a8,0xd9a859a8,0x0,0x0,0x59a8d9a8,0x59a859a8,0x0,0x0
.long 0x59a859a8,0x59a8d9a8,0x0,0x0,0xd9a859a8,0x59a859a8,0x0,0x0
.long 0xd9a859a8,0xd9a8d9a8,0x0,0x0,0xd9a8d9a8,0x59a8d9a8,0x0,0x0
.long 0xd9a8d9a8,0xd9a859a8,0x0,0x0,0x59a8d9a8,0xd9a8d9a8,0x0,0x0
.long 0x59a8d9a8,0x59a859a8,0x0,0x0,0x59a859a8,0xd9a859a8,0x0,0x0
.long 0xdb64561f,0x5b64561f,0x0,0x0,0x561f5b64,0x561fdb64,0x0,0x0
.long 0x561fdb64,0xd61fdb64,0x0,0x0,0xdb64d61f,0xdb64561f,0x0,0x0
.long 0x561f5b64,0xd61f5b64,0x0,0x0,0x5b64d61f,0x5b64561f,0x0,0x0
.long 0xdb64d61f,0x5b64d61f,0x0,0x0,0xd61f5b64,0xd61fdb64,0x0,0x0
.long 0xd61fdb64,0xd61f5b64,0x0,0x0,0x5b64d61f,0xdb64d61f,0x0,0x0
.long 0x5b64561f,0x5b64d61f,0x0,0x0,0xd61f5b64,0x561f5b64,0x0,0x0
.long 0xdb64561f,0xdb64d61f,0x0,0x0,0xd61fdb64,0x561fdb64,0x0,0x0
.long 0x561fdb64,0x561f5b64,0x0,0x0,0x5b64561f,0xdb64561f,0x0,0x0
.long 0xdc008000,0x5c000000,0x0,0x0,0x80005c00,0xdc00,0x0,0x0
.long 0x5c000000,0xdc008000,0x0,0x0,0xdc00,0x80005c00,0x0,0x0
.long 0xdc008000,0x5c000000,0x0,0x0,0x80005c00,0xdc00,0x0,0x0
.long 0x5c000000,0xdc008000,0x0,0x0,0xdc00,0x80005c00,0x0,0x0
.long 0x80005c00,0xdc00,0x0,0x0,0xdc008000,0x5c000000,0x0,0x0
.long 0xdc00,0x80005c00,0x0,0x0,0x5c000000,0xdc008000,0x0,0x0
.long 0x80005c00,0xdc00,0x0,0x0,0xdc008000,0x5c000000,0x0,0x0
.long 0xdc00,0x80005c00,0x0,0x0,0x5c000000,0xdc008000,0x0,0x0
.long 0xdb64d61f,0x5b64d61f,0x0,0x0,0xd61f5b64,0xd61fdb64,0x0,0x0
.long 0x561f5b64,0xd61f5b64,0x0,0x0,0x5b64d61f,0x5b64561f,0x0,0x0
.long 0x561fdb64,0xd61fdb64,0x0,0x0,0xdb64d61f,0xdb64561f,0x0,0x0
.long 0xdb64561f,0x5b64561f,0x0,0x0,0x561f5b64,0x561fdb64,0x0,0x0
.long 0x561fdb64,0x561f5b64,0x0,0x0,0x5b64561f,0xdb64561f,0x0,0x0
.long 0xdb64561f,0xdb64d61f,0x0,0x0,0xd61fdb64,0x561fdb64,0x0,0x0
.long 0x5b64561f,0x5b64d61f,0x0,0x0,0xd61f5b64,0x561f5b64,0x0,0x0
.long 0xd61fdb64,0xd61f5b64,0x0,0x0,0x5b64d61f,0xdb64d61f,0x0,0x0
.long 0xd9a8d9a8,0x59a8d9a8,0x0,0x0,0xd9a859a8,0xd9a8d9a8,0x0,0x0
.long 0xd9a859a8,0x59a859a8,0x0,0x0,0x59a859a8,0x59a8d9a8,0x0,0x0
.long 0x59a859a8,0xd9a859a8,0x0,0x0,0x59a8d9a8,0x59a859a8,0x0,0x0
.long 0x59a8d9a8,0xd9a8d9a8,0x0,0x0,0xd9a8d9a8,0xd9a859a8,0x0,0x0
.long 0xd9a859a8,0xd9a8d9a8,0x0,0x0,0xd9a8d9a8,0x59a8d9a8,0x0,0x0
.long 0x59a859a8,0x59a8d9a8,0x0,0x0,0xd9a859a8,0x59a859a8,0x0,0x0
.long 0x59a8d9a8,0x59a859a8,0x0,0x0,0x59a859a8,0xd9a859a8,0x0,0x0
.long 0xd9a8d9a8,0xd9a859a8,0x0,0x0,0x59a8d9a8,0xd9a8d9a8,0x0,0x0
.long 0xd61fdb64,0x561fdb64,0x0,0x0,0xdb64561f,0xdb64d61f,0x0,0x0
.long 0xdb64d61f,0x5b64d61f,0x0,0x0,0xd61f5b64,0xd61fdb64,0x0,0x0
.long 0xdb64561f,0x5b64561f,0x0,0x0,0x561f5b64,0x561fdb64,0x0,0x0
.long 0xd61f5b64,0x561f5b64,0x0,0x0,0x5b64561f,0x5b64d61f,0x0,0x0
.long 0x5b64d61f,0x5b64561f,0x0,0x0,0x561f5b64,0xd61f5b64,0x0,0x0
.long 0x561fdb64,0x561f5b64,0x0,0x0,0x5b64561f,0xdb64561f,0x0,0x0
.long 0xd61fdb64,0xd61f5b64,0x0,0x0,0x5b64d61f,0xdb64d61f,0x0,0x0
.long 0xdb64d61f,0xdb64561f,0x0,0x0,0x561fdb64,0xd61fdb64,0x0,0x0
.long 0x0,0x0,0x5c00,0x5c00,0x0,0x0,0x5c008000,0x5c008000
.long 0x0,0x0,0x5c00,0x5c00,0x0,0x0,0x5c008000,0x5c008000
.long 0x0,0x0,0x5c00,0x5c00,0x0,0x0,0x5c008000,0x5c008000
.long 0x0,0x0,0x5c00,0x5c00,0x0,0x0,0x5c008000,0x5c008000
.long 0x0,0x0,0x5c008000,0xdc008000,0x0,0x0,0x5c00,0xdc00
.long 0x0,0x0,0x5c008000,0xdc008000,0x0,0x0,0x5c00,0xdc00
.long 0x0,0x0,0x5c008000,0xdc008000,0x0,0x0,0x5c00,0xdc00
.long 0x0,0x0,0x5c008000,0xdc008000,0x0,0x0,0x5c00,0xdc00
.long 0x0,0x0,0x5c00,0x5c00,0x0,0x0,0x5c008000,0x5c008000
.long 0x0,0x0,0x59a859a8,0xd9a859a8,0x0,0x0,0x59a8d9a8,0x59a859a8
.long 0x0,0x0,0x5c000000,0xdc008000,0x0,0x0,0xdc00,0x80005c00
.long 0x0,0x0,0x59a8d9a8,0xd9a8d9a8,0x0,0x0,0xd9a8d9a8,0xd9a859a8
.long 0x0,0x0,0x5b64561f,0x5b64d61f,0x0,0x0,0xd61f5b64,0x561f5b64
.long 0x0,0x0,0x561f5b64,0x561fdb64,0x0,0x0,0xdb64561f,0x5b64561f
.long 0x0,0x0,0xd61f5b64,0xd61fdb64,0x0,0x0,0xdb64d61f,0x5b64d61f
.long 0x0,0x0,0xdb64561f,0xdb64d61f,0x0,0x0,0xd61fdb64,0x561fdb64
.long 0x0,0x0,0x5c00,0x5c00,0x0,0x0,0x5c008000,0x5c008000
.long 0x0,0x0,0x5c000000,0xdc008000,0x0,0x0,0xdc00,0x80005c00
.long 0x0,0x0,0xdc00,0xdc00,0x0,0x0,0xdc008000,0xdc008000
.long 0x0,0x0,0xdc008000,0x5c000000,0x0,0x0,0x80005c00,0xdc00
.long 0x0,0x0,0x59a859a8,0x59a8d9a8,0x0,0x0,0xd9a859a8,0x59a859a8
.long 0x0,0x0,0xd9a859a8,0xd9a8d9a8,0x0,0x0,0xd9a8d9a8,0x59a8d9a8
.long 0x0,0x0,0xd9a8d9a8,0xd9a859a8,0x0,0x0,0x59a8d9a8,0xd9a8d9a8
.long 0x0,0x0,0x59a8d9a8,0x59a859a8,0x0,0x0,0x59a859a8,0xd9a859a8
.long 0x0,0x0,0x5c00,0x5c00,0x0,0x0,0x5c008000,0x5c008000
.long 0x0,0x0,0x59a8d9a8,0xd9a8d9a8,0x0,0x0,0xd9a8d9a8,0xd9a859a8
.long 0x0,0x0,0xdc008000,0x5c000000,0x0,0x0,0x80005c00,0xdc00
.long 0x0,0x0,0x59a859a8,0xd9a859a8,0x0,0x0,0x59a8d9a8,0x59a859a8
.long 0x0,0x0,0x561f5b64,0x561fdb64,0x0,0x0,0xdb64561f,0x5b64561f
.long 0x0,0x0,0xdb64d61f,0xdb64561f,0x0,0x0,0x561fdb64,0xd61fdb64
.long 0x0,0x0,0x5b64d61f,0x5b64561f,0x0,0x0,0x561f5b64,0xd61f5b64
.long 0x0,0x0,0xd61f5b64,0xd61fdb64,0x0,0x0,0xdb64d61f,0x5b64d61f
.long 0x0,0x0,0x5c00,0x5c00,0x0,0x0,0x5c008000,0x5c008000
.long 0x0,0x0,0xdc00,0xdc00,0x0,0x0,0xdc008000,0xdc008000
.long 0x0,0x0,0x5c00,0x5c00,0x0,0x0,0x5c008000,0x5c008000
.long 0x0,0x0,0xdc00,0xdc00,0x0,0x0,0xdc008000,0xdc008000
.long 0x0,0x0,0x80005c00,0xdc00,0x0,0x0,0xdc008000,0x5c000000
.long 0x0,0x0,0xdc00,0x80005c00,0x0,0x0,0x5c000000,0xdc008000
.long 0x0,0x0,0x80005c00,0xdc00,0x0,0x0,0xdc008000,0x5c000000
.long 0x0,0x0,0xdc00,0x80005c00,0x0,0x0,0x5c000000,0xdc008000
.long 0x0,0x0,0x5c00,0x5c00,0x0,0x0,0x5c008000,0x5c008000
.long 0x0,0x0,0xd9a8d9a8,0x59a8d9a8,0x0,0x0,0xd9a859a8,0xd9a8d9a8
.long 0x0,0x0,0x5c000000,0xdc008000,0x0,0x0,0xdc00,0x80005c00
.long 0x0,0x0,0xd9a859a8,0x59a859a8,0x0,0x0,0x59a859a8,0x59a8d9a8
.long 0x0,0x0,0xd61f5b64,0xd61fdb64,0x0,0x0,0xdb64d61f,0x5b64d61f
.long 0x0,0x0,0x5b64d61f,0x5b64561f,0x0,0x0,0x561f5b64,0xd61f5b64
.long 0x0,0x0,0xdb64d61f,0xdb64561f,0x0,0x0,0x561fdb64,0xd61fdb64
.long 0x0,0x0,0x561f5b64,0x561fdb64,0x0,0x0,0xdb64561f,0x5b64561f
.long 0x0,0x0,0x5c00,0x5c00,0x0,0x0,0x5c008000,0x5c008000
.long 0x0,0x0,0xdc008000,0x5c000000,0x0,0x0,0x80005c00,0xdc00
.long 0x0,0x0,0xdc00,0xdc00,0x0,0x0,0xdc008000,0xdc008000
.long 0x0,0x0,0x5c000000,0xdc008000,0x0,0x0,0xdc00,0x80005c00
.long 0x0,0x0,0xd9a859a8,0xd9a8d9a8,0x0,0x0,0xd9a8d9a8,0x59a8d9a8
.long 0x0,0x0,0x59a859a8,0x59a8d9a8,0x0,0x0,0xd9a859a8,0x59a859a8
.long 0x0,0x0,0x59a8d9a8,0x59a859a8,0x0,0x0,0x59a859a8,0xd9a859a8
.long 0x0,0x0,0xd9a8d9a8,0xd9a859a8,0x0,0x0,0x59a8d9a8,0xd9a8d9a8
.long 0x0,0x0,0x5c00,0x5c00,0x0,0x0,0x5c008000,0x5c008000
.long 0x0,0x0,0xd9a859a8,0x59a859a8,0x0,0x0,0x59a859a8,0x59a8d9a8
.long 0x0,0x0,0xdc008000,0x5c000000,0x0,0x0,0x80005c00,0xdc00
.long 0x0,0x0,0xd9a8d9a8,0x59a8d9a8,0x0,0x0,0xd9a859a8,0xd9a8d9a8
.long 0x0,0x0,0xdb64561f,0xdb64d61f,0x0,0x0,0xd61fdb64,0x561fdb64
.long 0x0,0x0,0xd61f5b64,0xd61fdb64,0x0,0x0,0xdb64d61f,0x5b64d61f
.long 0x0,0x0,0x561f5b64,0x561fdb64,0x0,0x0,0xdb64561f,0x5b64561f
.long 0x0,0x0,0x5b64561f,0x5b64d61f,0x0,0x0,0xd61f5b64,0x561f5b64
.long 0x0,0x0,0x5c00,0x5c00,0x0,0x0,0x5c008000,0x5c008000
.long 0x0,0x0,0x5c00,0x5c00,0x0,0x0,0x5c008000,0x5c008000
.long 0x0,0x0,0x5c00,0x5c00,0x0,0x0,0x5c008000,0x5c008000
.long 0x0,0x0,0x5c00,0x5c00,0x0,0x0,0x5c008000,0x5c008000
.long 0x0,0x0,0x5c008000,0xdc008000,0x0,0x0,0x5c00,0xdc00
.long 0x0,0x0,0x5c008000,0xdc008000,0x0,0x0,0x5c00,0xdc00
.long 0x0,0x0,0x5c008000,0xdc008000,0x0,0x0,0x5c00,0xdc00
.long 0x0,0x0,0x5c008000,0xdc008000,0x0,0x0,0x5c00,0xdc00
.long 0x0,0x0,0xdc00,0xdc00,0x0,0x0,0xdc008000,0xdc008000
.long 0x0,0x0,0xd9a8d9a8,0x59a8d9a8,0x0,0x0,0xd9a859a8,0xd9a8d9a8
.long 0x0,0x0,0xdc008000,0x5c000000,0x0,0x0,0x80005c00,0xdc00
.long 0x0,0x0,0xd9a859a8,0x59a859a8,0x0,0x0,0x59a859a8,0x59a8d9a8
.long 0x0,0x0,0xdb64d61f,0xdb64561f,0x0,0x0,0x561fdb64,0xd61fdb64
.long 0x0,0x0,0xd61fdb64,0xd61f5b64,0x0,0x0,0x5b64d61f,0xdb64d61f
.long 0x0,0x0,0x561fdb64,0x561f5b64,0x0,0x0,0x5b64561f,0xdb64561f
.long 0x0,0x0,0x5b64d61f,0x5b64561f,0x0,0x0,0x561f5b64,0xd61f5b64
.long 0x0,0x0,0x5c00,0x5c00,0x0,0x0,0x5c008000,0x5c008000
.long 0x0,0x0,0x5c000000,0xdc008000,0x0,0x0,0xdc00,0x80005c00
.long 0x0,0x0,0xdc00,0xdc00,0x0,0x0,0xdc008000,0xdc008000
.long 0x0,0x0,0xdc008000,0x5c000000,0x0,0x0,0x80005c00,0xdc00
.long 0x0,0x0,0x59a859a8,0x59a8d9a8,0x0,0x0,0xd9a859a8,0x59a859a8
.long 0x0,0x0,0xd9a859a8,0xd9a8d9a8,0x0,0x0,0xd9a8d9a8,0x59a8d9a8
.long 0x0,0x0,0xd9a8d9a8,0xd9a859a8,0x0,0x0,0x59a8d9a8,0xd9a8d9a8
.long 0x0,0x0,0x59a8d9a8,0x59a859a8,0x0,0x0,0x59a859a8,0xd9a859a8
.long 0x0,0x0,0xdc00,0xdc00,0x0,0x0,0xdc008000,0xdc008000
.long 0x0,0x0,0xd9a859a8,0x59a859a8,0x0,0x0,0x59a859a8,0x59a8d9a8
.long 0x0,0x0,0x5c000000,0xdc008000,0x0,0x0,0xdc00,0x80005c00
.long 0x0,0x0,0xd9a8d9a8,0x59a8d9a8,0x0,0x0,0xd9a859a8,0xd9a8d9a8
.long 0x0,0x0,0xd61fdb64,0xd61f5b64,0x0,0x0,0x5b64d61f,0xdb64d61f
.long 0x0,0x0,0x5b64561f,0x5b64d61f,0x0,0x0,0xd61f5b64,0x561f5b64
.long 0x0,0x0,0xdb64561f,0xdb64d61f,0x0,0x0,0xd61fdb64,0x561fdb64
.long 0x0,0x0,0x561fdb64,0x561f5b64,0x0,0x0,0x5b64561f,0xdb64561f
.long 0x0,0x0,0x5c00,0x5c00,0x0,0x0,0x5c008000,0x5c008000
.long 0x0,0x0,0xdc00,0xdc00,0x0,0x0,0xdc008000,0xdc008000
.long 0x0,0x0,0x5c00,0x5c00,0x0,0x0,0x5c008000,0x5c008000
.long 0x0,0x0,0xdc00,0xdc00,0x0,0x0,0xdc008000,0xdc008000
.long 0x0,0x0,0x80005c00,0xdc00,0x0,0x0,0xdc008000,0x5c000000
.long 0x0,0x0,0xdc00,0x80005c00,0x0,0x0,0x5c000000,0xdc008000
.long 0x0,0x0,0x80005c00,0xdc00,0x0,0x0,0xdc008000,0x5c000000
.long 0x0,0x0,0xdc00,0x80005c00,0x0,0x0,0x5c000000,0xdc008000
.long 0x0,0x0,0xdc00,0xdc00,0x0,0x0,0xdc008000,0xdc008000
.long 0x0,0x0,0x59a859a8,0xd9a859a8,0x0,0x0,0x59a8d9a8,0x59a859a8
.long 0x0,0x0,0xdc008000,0x5c000000,0x0,0x0,0x80005c00,0xdc00
.long 0x0,0x0,0x59a8d9a8,0xd9a8d9a8,0x0,0x0,0xd9a8d9a8,0xd9a859a8
.long 0x0,0x0,0x561fdb64,0x561f5b64,0x0,0x0,0x5b64561f,0xdb64561f
.long 0x0,0x0,0xdb64561f,0xdb64d61f,0x0,0x0,0xd61fdb64,0x561fdb64
.long 0x0,0x0,0x5b64561f,0x5b64d61f,0x0,0x0,0xd61f5b64,0x561f5b64
.long 0x0,0x0,0xd61fdb64,0xd61f5b64,0x0,0x0,0x5b64d61f,0xdb64d61f
.long 0x0,0x0,0x5c00,0x5c00,0x0,0x0,0x5c008000,0x5c008000
.long 0x0,0x0,0xdc008000,0x5c000000,0x0,0x0,0x80005c00,0xdc00
.long 0x0,0x0,0xdc00,0xdc00,0x0,0x0,0xdc008000,0xdc008000
.long 0x0,0x0,0x5c000000,0xdc008000,0x0,0x0,0xdc00,0x80005c00
.long 0x0,0x0,0xd9a859a8,0xd9a8d9a8,0x0,0x0,0xd9a8d9a8,0x59a8d9a8
.long 0x0,0x0,0x59a859a8,0x59a8d9a8,0x0,0x0,0xd9a859a8,0x59a859a8
.long 0x0,0x0,0x59a8d9a8,0x59a859a8,0x0,0x0,0x59a859a8,0xd9a859a8
.long 0x0,0x0,0xd9a8d9a8,0xd9a859a8,0x0,0x0,0x59a8d9a8,0xd9a8d9a8
.long 0x0,0x0,0xdc00,0xdc00,0x0,0x0,0xdc008000,0xdc008000
.long 0x0,0x0,0x59a8d9a8,0xd9a8d9a8,0x0,0x0,0xd9a8d9a8,0xd9a859a8
.long 0x0,0x0,0x5c000000,0xdc008000,0x0,0x0,0xdc00,0x80005c00
.long 0x0,0x0,0x59a859a8,0xd9a859a8,0x0,0x0,0x59a8d9a8,0x59a859a8
.long 0x0,0x0,0x5b64d61f,0x5b64561f,0x0,0x0,0x561f5b64,0xd61f5b64
.long 0x0,0x0,0x561fdb64,0x561f5b64,0x0,0x0,0x5b64561f,0xdb64561f
.long 0x0,0x0,0xd61fdb64,0xd61f5b64,0x0,0x0,0x5b64d61f,0xdb64d61f
.long 0x0,0x0,0xdb64d61f,0xdb64561f,0x0,0x0,0x561fdb64,0xd61fdb64
.size fft_tables, 66560
.section .rodata,"a"
.p2align 6
.amdhsa_kernel interleave_layers__spectral_fnet__spectral_fnet__prompt_kernel
  .amdhsa_next_free_vgpr 256
  .amdhsa_next_free_sgpr 102
  .amdhsa_accum_offset 256
  .amdhsa_group_segment_fixed_size 0
  .amdhsa_kernarg_size 104
  .amdhsa_user_sgpr_count 2
  .amdhsa_user_sgpr_kernarg_segment_ptr 1
  .amdhsa_system_sgpr_workgroup_id_x 1
.end_amdhsa_kernel
```
